```python
import torch

def _softmax(x, axis=-1):
    return torch.softmax(x, dim=axis)
def _gelu(x):
    return torch.nn.functional.gelu(x, approximate="tanh")
def _silu(x):
    return torch.nn.functional.silu(x)
def _sigmoid(x):
    return torch.sigmoid(x)
def _layernorm(x, axis=-1, eps=1e-5):
    m = x.mean(dim=axis, keepdim=True)
    v = x.var(dim=axis, keepdim=True, unbiased=False)
    return (x - m) / torch.sqrt(v + eps)
def _scatter_add(tgt, idx, src, axis=0):
    return tgt.clone().index_add_(axis, idx, src)
def _segment_sum(src, seg, n):
    out = torch.zeros((n,) + src.shape[1:], dtype=src.dtype)
    return out.index_add_(0, seg, src)
def _pad(x, pw):
    flat = tuple(v for pair in reversed(pw) for v in pair)
    return torch.nn.functional.pad(x, flat)

kernel_name = 'parallel_sum__ssm_conv_h3__dense_activation_silu__prompt'

def setup_inputs():

    _w = (lambda a: (lambda t: t.to(torch.bfloat16) if t.is_floating_point() else t)(torch.as_tensor(a)))
    def _A_setup():
        B, S, D = 1, 2048, 448
        ks = 4
        return {
            "q": _w((lambda *s: torch.randn(*s, dtype=torch.bfloat16) * 0.05)(B, S, D)),
            "k": _w((lambda *s: torch.randn(*s, dtype=torch.bfloat16) * 0.2)(B, S, D)),
            "v": _w((lambda *s: torch.randn(*s, dtype=torch.bfloat16) * 0.2)(B, S, D)),
            "shift_k": _w((lambda *s: torch.randn(*s, dtype=torch.bfloat16) * 0.2)(D, ks) * 0.5),
            "ssm_k": _w((lambda *s: torch.randn(*s, dtype=torch.bfloat16) * 0.4)(D, S) * (1.0 / S ** 0.5)),
            "ssm_D": _w((lambda *s: torch.randn(*s, dtype=torch.bfloat16) * 0.2)(D)),
        }
    _A_in = _A_setup()

    def _B_setup():
        B, S, D, F = 1, 2048, 448, 1792
        return {
            "x": _w((lambda *s: torch.randn(*s, dtype=torch.bfloat16) * 0.05)(B, S, D)),
            "w1": _w((lambda *s: torch.randn(*s, dtype=torch.bfloat16) * 0.8)(D, F) * (D ** -0.5)),
            "w2": _w((lambda *s: torch.randn(*s, dtype=torch.bfloat16) * 0.1)(F, D) * (F ** -0.5)),
        }
    _B_in = _B_setup()

    return {
        "A_q": _A_in["q"],
        "A_k": _A_in["k"],
        "A_v": _A_in["v"],
        "A_shift_k": _A_in["shift_k"],
        "A_ssm_k": _A_in["ssm_k"],
        "A_ssm_D": _A_in["ssm_D"],
        "B_x": _B_in["x"],
        "B_w1": _B_in["w1"],
        "B_w2": _B_in["w2"],
    }

def reference(A_q, A_k, A_v, A_shift_k, A_ssm_k, A_ssm_D, B_x, B_w1, B_w2):
    def _A_ref(q, k, v, shift_k, ssm_k, ssm_D):
        B, S, D = q.shape
        ks = shift_k.shape[-1]
        k_pad = _pad(k, ((0, 0), (ks - 1, 0), (0, 0)))
        k_shift = torch.zeros_like(k)
        for t in range(ks):
            k_shift = k_shift + k_pad[:, t:t + S, :] * shift_k[:, ks - 1 - t][None, None, :]
        kv = k_shift * v
        L = 2 * S
        kv_pad = _pad(kv, ((0, 0), (0, S), (0, 0)))
        kf_pad = _pad(ssm_k, ((0, 0), (0, S)))
        kv_f = (lambda x, axes=(-2,-1): torch.fft.rfft2(x.float(), dim=axes))(kv_pad[:, None, :, :], axes=(1, 2))
        kf_f = (lambda x, axes=(-2,-1): torch.fft.rfft2(x.float(), dim=axes))(kf_pad[:, None, :], axes=(1, 2))
        kf_f = (lambda x, *d: x.permute(*d))(kf_f, 1, 2, 0)
        y_f = kv_f * kf_f[None, :, :, :]
        y = (lambda x, s, axes=(-2,-1): torch.fft.irfft2(x, s=s, dim=axes).to(torch.bfloat16))(y_f, (1, L), axes=(1, 2))[:, 0, :S, :]
        y = y + kv * ssm_D[None, None, :]
        return q * y

    def _B_ref(x, w1, w2):
        h = torch.einsum("bsd,df->bsf", x, w1)
        h = _silu(h)
        out = torch.einsum("bsf,fd->bsd", h, w2)
        return out

    x = A_q
    xn = _layernorm(x, axis=-1)
    return x + _A_ref(xn, A_k, A_v, A_shift_k, A_ssm_k, A_ssm_D) + _B_ref(xn, B_w1, B_w2)
```

```asm
; @launch grid=(256,1,1) block=(256,1,1) lds=163840
.amdgcn_target "amdgcn-amd-amdhsa--gfx950"
.text
.globl parallel_sum__ssm_conv_h3__dense_activation_silu__prompt_kernel
.p2align 8
.type parallel_sum__ssm_conv_h3__dense_activation_silu__prompt_kernel,@function
parallel_sum__ssm_conv_h3__dense_activation_silu__prompt_kernel:
    s_load_dwordx2 s[8:9], s[0:1], 0
    s_load_dwordx2 s[20:21], s[0:1], 56
    s_cmp_lt_u32 s2, 224
    s_cbranch_scc1 L_ffn
    s_getpc_b64 s[76:77]
L_pc:
    s_and_b32 s76, s76, 0xffffff00
    s_mov_b32 s78, L_codeend-parallel_sum__ssm_conv_h3__dense_activation_silu__prompt_kernel
    s_mov_b32 s79, 0x20000
    v_lshlrev_b32_e64 v2, 7, v0
    s_cmp_ge_u32 s2, 256
    s_cbranch_scc1 L_end
    buffer_load_dword v3, v2, s[76:79], 0 offen
    s_branch L_helper
L_ffn:
    v_lshrrev_b32 v2, 6, v0
    v_and_b32 v1, 63, v0
    s_and_b32 s48, s2, 7
    v_readfirstlane_b32 s3, v2
    s_lshr_b32 s49, s2, 3
    s_mov_b32 s10, 1835008
    s_mov_b32 s11, 0x20000
    s_mul_i32 s54, s49, 37
    s_lshr_b32 s54, s54, 8
    s_mul_i32 s4, s54, 7
    s_sub_u32 s55, s49, s4
    s_and_b32 s50, s48, 6
    s_lshl_b32 s50, s50, 1
    s_add_u32 s50, s50, s54
    s_add_u32 s7, s54, s55
    s_mul_i32 s7, s7, 3
    s_lshr_b32 s7, 71442704, s7
    s_and_b32 s7, s7, 7
    s_lshl_b32 s72, s3, 12
    v_lshrrev_b32 v2, 3, v1
    v_and_b32 v3, 7, v1
    v_lshrrev_b32_e64 v4, 4, v1
    v_mul_u32_u24 v34, 896, v2
    v_xor_b32 v36, v3, v4
    v_lshl_add_u32 v8, v36, 4, v34
    v_xor_b32 v36, 4, v36
    v_lshl_add_u32 v9, v36, 4, v34
    v_add_u32 v9, 6144, v9
    v_add_u32 v10, 12288, v8
    v_add_u32 v11, 12288, v9
    s_lshl_b32 s93, s50, 2
    s_add_u32 s93, s93, s3
    s_mul_i32 s93, s93, 28672
    s_lshl_b32 s6, s7, 7
    s_add_u32 s56, s93, s6
    s_add_u32 s96, s93, 896
    s_waitcnt lgkmcnt(0)
    s_add_u32 m0, s72, 0
    v_nop_e64
    buffer_load_dwordx4 v8, s[8:11], s56 offen offset:0 lds
    buffer_load_dwordx4 v9, s[8:11], s56 offen offset:1024 lds
    buffer_load_dwordx4 v10, s[8:11], s56 offen offset:2048 lds
    buffer_load_dwordx4 v11, s[8:11], s56 offen offset:3072 lds
    s_add_u32 s56, s56, 128
    s_cmp_eq_u32 s56, s96
    s_cselect_b32 s56, s93, s56
    s_and_b32 s51, s48, 1
    s_mul_i32 s51, s51, 7
    s_add_u32 s51, s51, s55
    s_mov_b32 s22, 1605632
    s_mov_b32 s23, 0x20000
    v_and_b32 v5, 15, v1
    v_lshrrev_b32 v6, 2, v5
    v_and_b32 v7, 3, v1
    v_xor_b32_e64 v36, v6, v4
    v_lshl_add_u32 v36, v36, 2, v7
    v_mul_u32_u24 v12, 3584, v4
    v_lshl_add_u32 v12, v36, 4, v12
    v_add_u32 v13, 13312, v12
    v_add_u32 v14, 26624, v12
    v_add_u32 v15, 39936, v12
    s_mul_i32 s95, s3, 57344
    s_lshl_b32 s6, s51, 8
    s_add_u32 s95, s95, s6
    s_add_u32 s97, s95, 1605632
    s_mul_i32 s57, s7, 229376
    s_add_u32 s57, s57, s95
    s_add_u32 m0, s72, 98304
    s_nop 0
    buffer_load_dwordx4 v12, s[20:23], s57 offen offset:0 lds
    buffer_load_dwordx4 v13, s[20:23], s57 offen offset:1024 lds
    buffer_load_dwordx4 v14, s[20:23], s57 offen offset:2048 lds
    buffer_load_dwordx4 v15, s[20:23], s57 offen offset:3072 lds
    s_add_u32 s57, s57, 229376
    s_cmp_eq_u32 s57, s97
    s_cselect_b32 s57, s95, s57
    s_load_dwordx2 s[12:13], s[0:1], 8
    s_load_dwordx2 s[16:17], s[0:1], 16
    s_load_dwordx2 s[32:33], s[0:1], 88
    s_load_dwordx2 s[40:41], s[0:1], 24
    s_load_dwordx2 s[28:29], s[0:1], 32
    s_load_dwordx2 s[44:45], s[0:1], 40
    s_load_dwordx2 s[24:25], s[0:1], 64
    s_load_dwordx2 s[36:37], s[0:1], 72
    s_mov_b32 s34, 11468800
    s_mov_b32 s35, 0x20000
    s_and_b32 s75, s3, 1
    s_mov_b32 s14, 1835008
    s_mov_b32 s15, 0x20000
    s_mov_b32 s18, 1835008
    s_mov_b32 s19, 0x20000
    s_mov_b32 s42, 3584
    s_mov_b32 s43, 0x20000
    s_lshl_b32 s52, s48, 2
    s_add_u32 s52, s52, s54
    s_mov_b32 s53, s55
    s_and_b32 s4, s3, 2
    v_bfe_u32 v36, v2, 1, 1
    v_or_b32 v36, s4, v36
    v_lshlrev_b32 v36, 1, v36
    v_xor_b32 v36, v36, v3
    v_lshl_add_u32 v32, v36, 4, v34
    v_lshrrev_b32 v33, 1, v1
    v_mul_u32_u24 v33, 896, v33
    v_and_b32 v36, 1, v1
    v_lshl_add_u32 v33, v36, 4, v33
    s_mul_i32 s4, s52, 57344
    s_lshl_b32 s5, s53, 7
    s_add_u32 s4, s4, s5
    s_lshl_b32 s5, s3, 5
    s_add_u32 s5, s5, s4
    s_sub_u32 s5, s5, 3584
    v_add_u32 v33, s5, v33
    s_mul_i32 s5, s3, 7168
    s_add_u32 s98, s4, s5
    s_add_u32 s99, s98, 28672
    s_lshl_b32 s6, s53, 6
    s_lshl_b32 s7, s3, 4
    s_add_u32 s6, s6, s7
    v_add_lshl_u32 v35, v5, s6, 3
    s_lshl_b32 s100, s3, 10
    s_lshl_b32 s101, s3, 7
    v_mov_b32_e64 v49, 0
    s_waitcnt lgkmcnt(0)
    s_add_u32 m0, s100, 114688
    v_nop_e64
    buffer_load_dwordx4 v32, s[12:15], s98 offen nt lds
    s_mov_b32 s30, 1835008
    s_mov_b32 s31, 0x20000
    s_lshl_b32 s6, s2, 2
    s_load_dword s46, s[44:45], s6
    s_lshl_b32 s73, s2, 1
    s_add_u32 m0, s100, 118784
    s_nop 0
    buffer_load_dwordx4 v32, s[12:15], s99 offen nt lds
    s_lshr_b32 s76, s3, 1
    s_mov_b32 s74, 0xffff0000
    v_lshlrev_b32 v28, 4, v1
    s_add_u32 s4, s73, s76
    s_lshl_b32 s61, s4, 12
    v_and_b32 v38, 1, v4
    s_add_u32 m0, s100, 122880
    s_nop 0
    buffer_load_dwordx4 v32, s[16:19], s98 offen nt lds
    s_lshl_b32 s4, s75, 11
    v_add_u32 v36, s4, v28
    s_mul_i32 s5, s76, 21248
    v_subrev_u32 v37, 8, v36
    s_add_u32 s5, s5, 114720
    v_add_u32 v39, s5, v36
    v_lshrrev_b32 v0, 5, v1
    v_and_b32 v31, 31, v1
    s_lshl_b32 s6, s75, 1
    s_add_u32 m0, s100, 126976
    s_nop 0
    buffer_load_dwordx4 v32, s[16:19], s99 offen nt lds
    s_add_u32 s6, s6, s76
    v_lshl_add_u32 v46, v0, 3, v6
    v_lshlrev_b32_e64 v46, 8, v46
    v_lshl_add_u32 v46, v38, 5, v46
    v_lshl_add_u32 v46, v7, 3, v46
    s_add_u32 m0, s101, 157184
    s_mov_b64 exec, 0xff
    buffer_load_dwordx4 v33, s[12:15], 0 offen nt lds
    s_mov_b64 exec, -1
    v_add_u32 v46, 65536, v46
    v_xor_b32 v47, s6, v6
    v_lshl_add_u32 v20, v47, 6, v46
    v_xor_b32 v21, 64, v20
    s_lshl_b32 s7, s76, 13
    v_lshlrev_b32_e64 v46, 7, v31
    buffer_load_dwordx2 v[50:51], v35, s[40:43], 0 offen
    v_add_u32 v46, s7, v46
    v_bfe_u32 v47, v31, 1, 3
    v_xor_b32 v47, v47, v0
    v_lshl_add_u32 v22, v47, 4, v46
    v_xor_b32 v23, 32, v22
    v_xor_b32 v24, 64, v22
    buffer_load_dword v49, v49, s[32:35], 0 offen sc1
    v_xor_b32 v25, 96, v22
    v_cmp_eq_u32_e64 vcc, v5, v38
    v_mov_b32 v46, 0x3f803f80
    s_nop 0
    v_cndmask_b32 v164, 0, v46, vcc
    v_mov_b32 v165, v164
    v_mov_b32 v166, v164
    v_mov_b32 v167, v164
    v_lshrrev_b32 v34, 1, v1
    v_mul_u32_u24 v34, 4160, v34
    v_and_b32_e64 v255, 1, v1
    v_lshl_add_u32 v34, v255, 4, v34
    s_mul_i32 s5, s76, 21248
    s_add_u32 s5, s5, 114688
    v_add_u32 v34, s5, v34
    s_add_u32 s5, s5, 16640
    v_lshlrev_b32 v255, 3, v1
    v_add_u32_e64 v255, s5, v255
    v_lshl_add_u32 v40, v4, 4, v6
    v_lshlrev_b32 v40, 7, v40
    v_lshl_add_u32 v40, v7, 3, v40
    v_add_u32 v40, 114688, v40
    v_lshrrev_b32 v42, 1, v6
    v_lshl_add_u32 v42, v38, 1, v42
    v_xor_b32 v42, s3, v42
    v_lshl_add_u32 v40, v42, 5, v40
    v_subrev_u32 v41, 512, v40
    v_xor_b32 v41, 64, v41
    s_lshl_b32 s4, s3, 7
    s_add_u32 s4, s4, 157184
    v_lshlrev_b32 v42, 5, v6
    v_lshl_add_u32 v42, v7, 3, v42
    v_add_u32 v42, s4, v42
    v_cmp_eq_u32 vcc, 0, v4
    s_mul_i32 s4, s75, 2304
    s_mul_i32 s5, s76, 21248
    s_add_u32 s4, s4, s5
    s_add_u32 s4, s4, 131328
    v_cndmask_b32 v41, v41, v42, vcc
    v_mul_u32_u24 v43, 144, v5
    v_lshl_add_u32 v43, v4, 5, v43
    v_add_u32 v43, s4, v43
    v_lshl_add_u32 v44, v2, 4, v28
    v_add_u32 v44, s4, v44
    v_lshlrev_b32_e64 v45, 12, v2
    v_lshl_add_u32 v45, v3, 4, v45
    s_mov_b32 s26, 1605632
    s_mov_b32 s27, 0x20000
    s_mov_b32 s38, 1835008
    s_mov_b32 s39, 0x20000
    v_lshrrev_b32 v46, 3, v1
    v_and_b32 v47, 7, v1
    v_bfe_u32 v48, v46, 1, 1
    v_lshlrev_b32 v48, 2, v48
    v_xor_b32 v48, v48, v47
    v_mul_u32_u24 v46, 896, v46
    v_lshl_add_u32 v16, v48, 4, v46
    v_add_u32 v17, 6144, v16
    v_add_u32 v18, 12288, v16
    v_add_u32 v19, 18432, v16
    v_and_b32 v48, 1, v4
    v_lshl_add_u32 v46, v0, 2, v6
    v_lshlrev_b32 v46, 7, v46
    v_add_u32 v46, s72, v46
    v_and_b32 v47, 1, v7
    v_lshl_add_u32 v46, v47, 5, v46
    v_lshl_add_u32 v46, v48, 4, v46
    v_lshrrev_b32_e64 v47, 1, v7
    v_lshl_add_u32 v46, v47, 3, v46
    v_lshrrev_b32 v47, 1, v6
    v_xor_b32 v47, s75, v47
    v_lshl_add_u32 v26, v47, 6, v46
    v_xor_b32_e64 v27, 64, v26
    s_mul_i32 s6, s76, 21248
    s_lshl_b32 s7, s75, 8
    s_add_u32 s4, s7, s6
    s_add_u32 s4, s4, 114696
    v_mul_u32_u24 v29, 4160, v6
    buffer_load_dwordx4 v[230:233], v36, s[28:31], s61 offen nt
    v_lshl_add_u32 v29, v7, 3, v29
    v_lshl_add_u32 v29, v4, 4, v29
    v_add_u32 v29, s4, v29
    s_sub_u32 s4, s6, s7
    s_add_u32 s4, s4, 131664
    v_lshlrev_b32 v30, 5, v5
    v_lshlrev_b32 v46, 4, v4
    v_sub_u32 v30, v30, v46
    v_add_u32 v30, s4, v30
    s_lshl_b32 s4, s53, 2
    s_add_u32 s4, s4, s3
    s_lshl_b32 s77, s4, 16
    s_lshl_b32 s5, s52, 7
    s_add_u32 s77, s77, s5
    s_add_u32 s77, s77, 65536
    s_add_u32 s78, s77, 32768
    s_lshl_b32 s79, s4, 5
    s_add_u32 s79, s79, s52
    s_lshl_b32 s79, s79, 7
    s_add_u32 s79, s79, 11075584
    s_mov_b32 s7, 0
    s_mul_i32 s40, s3, 401408
    s_lshl_b32 s6, s53, 7
    s_add_u32 s40, s40, s6
    s_add_u32 s41, s40, 401408
    s_mul_i32 s58, s7, 28672
    s_add_u32 s58, s58, s40
    s_mul_i32 s65, s52, 229376
    s_mul_i32 s6, s3, 28672
    s_add_u32 s65, s65, s6
    s_add_u32 s65, s65, 3735552
    s_add_u32 s42, s65, 28672
    s_lshl_b32 s59, s7, 11
    s_add_u32 s59, s59, s65
    s_lshl_b32 s6, s50, 1
    s_add_u32 s6, s6, s76
    s_mov_b64 exec, 1
    buffer_load_dwordx2 v[228:229], v37, s[28:31], s61 offen nt
    s_mov_b64 exec, -1
    s_lshl_b32 s7, s51, 1
    s_add_u32 s7, s7, s75
    s_lshl_b32 s80, s6, 5
    s_add_u32 s80, s80, s7
    s_lshl_b32 s80, s80, 7
    s_add_u32 s80, s80, 11206656
    s_lshl_b32 s55, s6, 9
    s_add_u32 s55, s55, 16384
    s_mul_i32 s6, s6, 224
    s_lshl_b32 s7, s7, 2
    s_add_u32 s6, s6, s7
    s_lshl_b32 s6, s6, 10
    s_add_u32 s6, s6, 3735552
    s_lshl_b32 s7, s76, 11
    s_add_u32 s67, s6, s7
    s_add_u32 s68, s67, 114688
    s_xor_b32 s7, s7, 2048
    s_add_u32 s69, s6, s7
    s_add_u32 s70, s69, 114688
    s_add_u32 s4, s73, s76
    s_mul_i32 s81, s75, 448
    s_add_u32 s81, s81, s4
    s_lshl_b32 s81, s81, 7
    s_add_u32 s81, s81, 11337728
    s_lshl_b32 s5, s75, 11
    s_add_u32 s4, s61, s5
    s_add_u32 s60, s4, 65536
    s_add_u32 s63, s4, 1900544
    s_mul_i32 s62, s76, 21248
    s_add_u32 s62, s62, s5
    s_add_u32 s62, s62, 131840
    s_lshr_b32 s48, s73, 4
    s_lshl_b32 s48, s48, 12
    s_add_u32 s48, s48, 11075584
    s_lshl_b32 s4, s52, 1
    s_add_u32 s4, s4, s76
    s_lshl_b32 s5, s53, 1
    s_add_u32 s5, s5, s75
    s_mul_i32 s64, s4, 28672
    s_lshl_b32 s6, s5, 6
    s_add_u32 s64, s64, s6
    s_add_u32 s66, s64, 13312
    buffer_load_dwordx4 v[236:239], v36, s[28:31], s61 offen offset:1024 nt
    s_lshl_b32 s50, s4, 8
    s_add_u32 s50, s50, 16384
    s_lshl_b32 s0, s5, 17
    s_lshl_b32 s6, s4, 6
    s_add_u32 s0, s0, s6
    s_add_u32 s0, s0, 1900544
    s_add_u32 s1, s0, 64512
    s_lshl_b32 s54, s5, 12
    s_lshr_b32 s6, s52, 4
    s_mul_i32 s6, s6, 57344
    s_add_u32 s54, s54, s6
    s_add_u32 s54, s54, 11337728
    s_lshl_b32 s49, s52, 5
    s_mul_i32 s6, s3, 7
    s_add_u32 s49, s49, s6
    s_lshl_b32 s49, s49, 7
    s_add_u32 s49, s49, 11206656
    v_lshlrev_b32 v46, 3, v31
    v_lshlrev_b32 v48, 7, v1
    s_lshl_b32 s4, s75, 8
    s_lshl_b32 s6, s76, 7
    s_add_u32 s4, s4, 163328
    s_add_u32 s6, s4, s6
    v_lshlrev_b32 v252, 6, v5
    v_lshl_add_u32 v252, v4, 4, v252
    v_add_u32 v252, s6, v252
    v_lshlrev_b32 v253, 4, v0
    v_add_u32_e64 v253, s6, v253
    v_xor_b32 v254, 128, v253
    s_mul_i32 s7, s76, 114688
    v_add_u32 v192, s7, v28
    s_sub_u32 s7, 114688, s7
    v_add_u32 v193, s7, v28
    v_lshrrev_b32 v199, 2, v1
    v_mul_u32_u24 v194, 896, v199
    v_lshl_add_u32 v194, v7, 4, v194
    v_lshlrev_b32 v195, 12, v199
    v_lshl_add_u32 v195, v7, 4, v195
    s_add_u32 s7, s72, 98304
    v_add_u32_e64 v244, s7, v28
    v_xor_b32 v245, 4096, v244
    v_add_u32 v248, 65536, v26
    v_add_u32 v249, 65536, v27
    v_lshlrev_b32 v247, 5, v5
    v_lshl_add_u32 v247, v4, 3, v247
    v_add_u32_e64 v246, s62, v247
    s_waitcnt vmcnt(10)
    s_waitcnt lgkmcnt(0)
    s_barrier
    ds_read_b64_tr_b16 v[128:129], v20 offset:32768
    ds_read_b64_tr_b16 v[130:131], v20 offset:33792
    ds_read_b128 v[136:139], v22 offset:0
    ds_read_b128 v[140:143], v22 offset:4096
    ds_read_b64_tr_b16 v[132:133], v21 offset:32768
    ds_read_b64_tr_b16 v[134:135], v21 offset:33792
    ds_read_b64_tr_b16 v[144:145], v20 offset:36864
    ds_read_b64_tr_b16 v[146:147], v20 offset:37888
    ds_read_b128 v[152:155], v23 offset:0
    ds_read_b128 v[156:159], v23 offset:4096
    ds_read_b64_tr_b16 v[148:149], v21 offset:36864
    ds_read_b64_tr_b16 v[150:151], v21 offset:37888
    s_add_u32 m0, s72, 16384
    v_nop_e64
    buffer_load_dwordx4 v8, s[8:11], s56 offen offset:0 lds
    buffer_load_dwordx4 v9, s[8:11], s56 offen offset:1024 lds
    buffer_load_dwordx4 v10, s[8:11], s56 offen offset:2048 lds
    buffer_load_dwordx4 v11, s[8:11], s56 offen offset:3072 lds
    s_add_u32 s56, s56, 128
    s_cmp_eq_u32 s56, s96
    s_cselect_b32 s56, s93, s56
    s_add_u32 m0, s72, 65536
    v_nop_e64
    buffer_load_dwordx4 v12, s[20:23], s57 offen offset:0 lds
    buffer_load_dwordx4 v13, s[20:23], s57 offen offset:1024 lds
    buffer_load_dwordx4 v14, s[20:23], s57 offen offset:2048 lds
    buffer_load_dwordx4 v15, s[20:23], s57 offen offset:3072 lds
    s_add_u32 s57, s57, 229376
    s_cmp_eq_u32 s57, s97
    s_cselect_b32 s57, s95, s57
    s_waitcnt lgkmcnt(6)
    v_mfma_f32_16x16x32_bf16 v[160:163], v[128:131], v[164:167], 0
    ds_read_b64_tr_b16 v[200:201], v20 offset:40960
    v_mfma_f32_32x32x16_bf16 v[64:79], v[128:131], v[136:139], 0
    ds_read_b64_tr_b16 v[202:203], v20 offset:41984
    ds_read_b128 v[208:211], v24 offset:0
    ds_read_b128 v[212:215], v24 offset:4096
    s_lshl_b32 s7, s46, 16
    s_and_b32 s46, s46, s74
    v_mfma_f32_32x32x16_bf16 v[80:95], v[128:131], v[140:143], 0
    ds_read_b64_tr_b16 v[204:205], v21 offset:40960
    ds_read_b64_tr_b16 v[206:207], v21 offset:41984
    s_cmp_eq_u32 s76, 0
    s_cselect_b32 s46, s7, s46
    v_mfma_f32_32x32x16_bf16 v[96:111], v[132:135], v[136:139], 0
    v_mfma_f32_32x32x16_bf16 v[112:127], v[132:135], v[140:143], 0
    s_waitcnt lgkmcnt(6)
    v_mfma_f32_16x16x32_bf16 v[160:163], v[144:147], v[164:167], v[160:163]
    ds_read_b64_tr_b16 v[128:129], v20 offset:45056
    v_mfma_f32_32x32x16_bf16 v[64:79], v[144:147], v[152:155], v[64:79]
    ds_read_b64_tr_b16 v[130:131], v20 offset:46080
    ds_read_b128 v[136:139], v25 offset:0
    ds_read_b128 v[140:143], v25 offset:4096
    v_mfma_f32_32x32x16_bf16 v[80:95], v[144:147], v[156:159], v[80:95]
    ds_read_b64_tr_b16 v[132:133], v21 offset:45056
    ds_read_b64_tr_b16 v[134:135], v21 offset:46080
    v_mfma_f32_32x32x16_bf16 v[96:111], v[148:151], v[152:155], v[96:111]
    v_mfma_f32_32x32x16_bf16 v[112:127], v[148:151], v[156:159], v[112:127]
    s_waitcnt vmcnt(11)
    s_barrier
    ds_read_b64_tr_b16 v[168:169], v41
    ds_read_b64_tr_b16 v[170:171], v40 offset:0
    ds_read_b64_tr_b16 v[172:173], v40 offset:512
    ds_read_b64_tr_b16 v[174:175], v40 offset:1024
    ds_read_b64_tr_b16 v[176:177], v40 offset:1536
    ds_read_b64_tr_b16 v[178:179], v40 offset:8192
    ds_read_b64_tr_b16 v[180:181], v40 offset:8704
    ds_read_b64_tr_b16 v[182:183], v40 offset:9216
    ds_read_b64_tr_b16 v[184:185], v40 offset:9728
    v_readfirstlane_b32 s47, v49
    s_add_u32 m0, s72, 32768
    s_nop 0
    buffer_load_dwordx4 v8, s[8:11], s56 offen offset:0 lds
    v_alignbit_b32 v52, v50, v50, 16
    v_alignbit_b32 v53, v51, v51, 16
    v_and_b32 v54, 0xffff, v50
    v_bfi_b32 v55, s74, v50, v51
    v_and_b32_e64 v51, s74, v51
    s_add_u32 s47, s47, 1
    s_waitcnt lgkmcnt(4)
    v_dot2_f32_bf16 v216, v168, v51, 0
    v_dot2_f32_bf16 v217, v169, v53, 0
    v_dot2_f32_bf16 v218, v169, v51, 0
    v_dot2_f32_bf16 v219, v170, v53, 0
    v_dot2_f32_bf16 v220, v170, v51, 0
    v_dot2_f32_bf16 v221, v171, v53, 0
    v_dot2_f32_bf16 v222, v171, v51, 0
    v_dot2_f32_bf16 v223, v172, v53, 0
    v_dot2_f32_bf16 v224, v172, v51, 0
    v_dot2_f32_bf16 v225, v173, v53, 0
    v_dot2_f32_bf16 v226, v173, v51, 0
    v_dot2_f32_bf16 v227, v174, v53, 0
    v_dot2_f32_bf16 v240, v174, v51, 0
    v_dot2_f32_bf16 v241, v175, v53, 0
    v_dot2_f32_bf16 v242, v175, v51, 0
    v_dot2_f32_bf16 v243, v176, v53, 0
    v_dot2_f32_bf16 v216, v169, v55, v216
    v_dot2_f32_bf16 v217, v170, v52, v217
    v_dot2_f32_bf16 v218, v170, v55, v218
    v_dot2_f32_bf16 v219, v171, v52, v219
    v_dot2_f32_bf16 v220, v171, v55, v220
    v_dot2_f32_bf16 v221, v172, v52, v221
    v_dot2_f32_bf16 v222, v172, v55, v222
    buffer_load_dwordx4 v9, s[8:11], s56 offen offset:1024 lds
    v_dot2_f32_bf16 v223, v173, v52, v223
    v_dot2_f32_bf16 v224, v173, v55, v224
    v_dot2_f32_bf16 v225, v174, v52, v225
    v_dot2_f32_bf16 v226, v174, v55, v226
    v_dot2_f32_bf16 v227, v175, v52, v227
    v_dot2_f32_bf16 v240, v175, v55, v240
    v_dot2_f32_bf16 v241, v176, v52, v241
    v_dot2_f32_bf16 v242, v176, v55, v242
    v_dot2_f32_bf16 v243, v177, v52, v243
    v_dot2_f32_bf16 v216, v170, v54, v216
    v_dot2_f32_bf16 v218, v171, v54, v218
    v_dot2_f32_bf16 v220, v172, v54, v220
    v_dot2_f32_bf16 v222, v173, v54, v222
    v_dot2_f32_bf16 v224, v174, v54, v224
    v_dot2_f32_bf16 v226, v175, v54, v226
    v_dot2_f32_bf16 v240, v176, v54, v240
    v_dot2_f32_bf16 v242, v177, v54, v242
    s_waitcnt lgkmcnt(0)
    v_lshlrev_b32 v186, 16, v178
    v_and_b32_e64 v187, s74, v178
    v_pk_mul_f32 v[216:217], v[216:217], v[186:187]
    v_lshlrev_b32 v188, 16, v179
    v_and_b32 v189, s74, v179
    v_pk_mul_f32 v[218:219], v[218:219], v[188:189]
    v_lshlrev_b32 v186, 16, v180
    v_and_b32 v187, s74, v180
    v_pk_mul_f32 v[220:221], v[220:221], v[186:187]
    v_lshlrev_b32 v188, 16, v181
    v_and_b32 v189, s74, v181
    v_pk_mul_f32 v[222:223], v[222:223], v[188:189]
    v_lshlrev_b32_e64 v186, 16, v182
    buffer_load_dwordx4 v10, s[8:11], s56 offen offset:2048 lds
    v_and_b32 v187, s74, v182
    v_pk_mul_f32 v[224:225], v[224:225], v[186:187]
    v_lshlrev_b32 v188, 16, v183
    v_and_b32_e64 v189, s74, v183
    v_pk_mul_f32 v[226:227], v[226:227], v[188:189]
    v_lshlrev_b32 v186, 16, v184
    v_and_b32 v187, s74, v184
    v_pk_mul_f32 v[240:241], v[240:241], v[186:187]
    v_lshlrev_b32 v188, 16, v185
    v_and_b32 v189, s74, v185
    v_pk_mul_f32 v[242:243], v[242:243], v[188:189]
    v_cvt_pk_bf16_f32 v56, v216, v217
    v_cvt_pk_bf16_f32 v57, v218, v219
    v_cvt_pk_bf16_f32 v58, v220, v221
    v_cvt_pk_bf16_f32 v59, v222, v223
    v_cvt_pk_bf16_f32 v60, v224, v225
    v_cvt_pk_bf16_f32 v61, v226, v227
    v_cvt_pk_bf16_f32 v62, v240, v241
    v_cvt_pk_bf16_f32 v63, v242, v243
    s_barrier
    ds_write_b128 v43, v[56:59]
    ds_write_b128 v43, v[60:63] offset:16
    s_waitcnt vmcnt(11)
    v_mov_b32_dpp v228, v232 wave_shr:1 row_mask:0xf bank_mask:0xf
    v_mov_b32_dpp v229, v233 wave_shr:1 row_mask:0xf bank_mask:0xf
    v_mov_b32_dpp v234, v232 wave_ror:1 row_mask:0xf bank_mask:0xf
    v_mov_b32_dpp v235, v233 wave_ror:1 row_mask:0xf bank_mask:0xf
    v_mov_b32_dpp v234, v238 wave_shr:1 row_mask:0xf bank_mask:0xf
    v_mov_b32_dpp v235, v239 wave_shr:1 row_mask:0xf bank_mask:0xf
    v_alignbit_b32 v168, v230, v229, 16
    v_alignbit_b32 v169, v231, v230, 16
    v_alignbit_b32 v170, v232, v231, 16
    v_alignbit_b32 v171, v233, v232, 16
    v_mov_b32 v172, v229
    v_mov_b32 v173, v230
    v_mov_b32_e64 v174, v231
    v_mov_b32 v175, v232
    v_alignbit_b32 v176, v229, v228, 16
    buffer_load_dwordx4 v11, s[8:11], s56 offen offset:3072 lds
    s_add_u32 s56, s56, 128
    s_cmp_eq_u32 s56, s96
    s_cselect_b32 s56, s93, s56
    v_alignbit_b32 v177, v230, v229, 16
    v_alignbit_b32 v178, v231, v230, 16
    v_alignbit_b32 v179, v232, v231, 16
    s_waitcnt lgkmcnt(0)
    ds_read_b128 v[56:59], v44
    ds_read_b128 v[60:63], v44 offset:1152
    v_alignbit_b32 v180, v236, v235, 16
    v_alignbit_b32 v181, v237, v236, 16
    v_alignbit_b32 v182, v238, v237, 16
    v_alignbit_b32 v183, v239, v238, 16
    v_mov_b32 v216, v235
    v_mov_b32 v217, v236
    v_mov_b32 v218, v237
    v_mov_b32 v219, v238
    v_alignbit_b32 v220, v235, v234, 16
    v_alignbit_b32 v221, v236, v235, 16
    v_alignbit_b32 v222, v237, v236, 16
    v_alignbit_b32 v223, v238, v237, 16
    s_waitcnt lgkmcnt(1)
    buffer_store_dwordx4 v[56:59], v45, s[32:35], s77 offen sc1
    s_waitcnt lgkmcnt(0)
    buffer_store_dwordx4 v[60:63], v45, s[32:35], s78 offen sc1
    v_mov_b32 v240, 0
    v_mov_b32 v241, 0
    v_mov_b32 v242, 0
    v_mov_b32_e64 v243, 0
    s_mov_b64 exec, 0xff
    ds_write_b128 v34, v[240:243]
    s_mov_b64 exec, -1
    ds_write_b128 v39, v[230:233] offset:0
    ds_write_b128 v39, v[168:171] offset:4160
    ds_write_b128 v39, v[172:175] offset:8320
    ds_write_b128 v39, v[176:179] offset:12480
    ds_write_b128 v39, v[236:239] offset:1024
    ds_write_b128 v39, v[180:183] offset:5184
    ds_write_b128 v39, v[216:219] offset:9344
    ds_write_b128 v39, v[220:223] offset:13504
    s_cmp_eq_u32 s75, 0
    s_cselect_b64 exec, -1, 0
    ds_write_b64 v255, v[240:241]
    s_mov_b64 exec, -1
    v_mfma_f32_16x16x32_bf16 v[160:163], v[200:203], v[164:167], v[160:163]
    v_mfma_f32_32x32x16_bf16 v[64:79], v[200:203], v[208:211], v[64:79]
    s_waitcnt vmcnt(6)
    s_barrier
    ds_read_b64_tr_b16 v[144:145], v20 offset:0
    ds_read_b64_tr_b16 v[146:147], v20 offset:1024
    s_add_u32 m0, s72, 81920
    s_nop 0
    buffer_load_dwordx4 v12, s[20:23], s57 offen offset:0 lds
    v_mfma_f32_32x32x16_bf16 v[80:95], v[200:203], v[212:215], v[80:95]
    ds_read_b128 v[152:155], v22 offset:16384
    ds_read_b128 v[156:159], v22 offset:20480
    ds_read_b64_tr_b16 v[148:149], v21 offset:0
    ds_read_b64_tr_b16 v[150:151], v21 offset:1024
    buffer_load_dwordx4 v13, s[20:23], s57 offen offset:1024 lds
    v_mfma_f32_32x32x16_bf16 v[96:111], v[204:207], v[208:211], v[96:111]
    buffer_load_dwordx4 v14, s[20:23], s57 offen offset:2048 lds
    v_mfma_f32_32x32x16_bf16 v[112:127], v[204:207], v[212:215], v[112:127]
    buffer_load_dwordx4 v15, s[20:23], s57 offen offset:3072 lds
    s_add_u32 s57, s57, 229376
    s_cmp_eq_u32 s57, s97
    s_cselect_b32 s57, s95, s57
    v_mfma_f32_16x16x32_bf16 v[160:163], v[128:131], v[164:167], v[160:163]
    ds_read_b64_tr_b16 v[200:201], v20 offset:4096
    v_mfma_f32_32x32x16_bf16 v[64:79], v[128:131], v[136:139], v[64:79]
    ds_read_b64_tr_b16 v[202:203], v20 offset:5120
    ds_read_b128 v[208:211], v23 offset:16384
    ds_read_b128 v[212:215], v23 offset:20480
    s_add_u32 m0, s72, 49152
    v_nop_e64
    buffer_load_dwordx4 v8, s[8:11], s56 offen offset:0 lds
    v_mfma_f32_32x32x16_bf16 v[80:95], v[128:131], v[140:143], v[80:95]
    ds_read_b64_tr_b16 v[204:205], v21 offset:4096
    ds_read_b64_tr_b16 v[206:207], v21 offset:5120
    buffer_load_dwordx4 v9, s[8:11], s56 offen offset:1024 lds
    v_mfma_f32_32x32x16_bf16 v[96:111], v[132:135], v[136:139], v[96:111]
    buffer_load_dwordx4 v10, s[8:11], s56 offen offset:2048 lds
    v_mfma_f32_32x32x16_bf16 v[112:127], v[132:135], v[140:143], v[112:127]
    buffer_load_dwordx4 v11, s[8:11], s56 offen offset:3072 lds
    s_add_u32 s56, s56, 128
    s_cmp_eq_u32 s56, s96
    s_cselect_b32 s56, s93, s56
    s_waitcnt lgkmcnt(6)
    v_mfma_f32_16x16x32_bf16 v[160:163], v[144:147], v[164:167], v[160:163]
    ds_read_b64_tr_b16 v[128:129], v20 offset:8192
    v_mfma_f32_32x32x16_bf16 v[64:79], v[144:147], v[152:155], v[64:79]
    ds_read_b64_tr_b16 v[130:131], v20 offset:9216
    ds_read_b128 v[136:139], v24 offset:16384
    ds_read_b128 v[140:143], v24 offset:20480
    v_mfma_f32_32x32x16_bf16 v[80:95], v[144:147], v[156:159], v[80:95]
    ds_read_b64_tr_b16 v[132:133], v21 offset:8192
    ds_read_b64_tr_b16 v[134:135], v21 offset:9216
    v_mfma_f32_32x32x16_bf16 v[96:111], v[148:151], v[152:155], v[96:111]
    s_add_u32 m0, s72, 98304
    s_nop 0
    buffer_load_dwordx4 v12, s[20:23], s57 offen offset:0 lds
    v_mfma_f32_32x32x16_bf16 v[112:127], v[148:151], v[156:159], v[112:127]
    buffer_load_dwordx4 v13, s[20:23], s57 offen offset:1024 lds
    s_waitcnt lgkmcnt(6)
    v_mfma_f32_16x16x32_bf16 v[160:163], v[200:203], v[164:167], v[160:163]
    ds_read_b64_tr_b16 v[144:145], v20 offset:12288
    v_mfma_f32_32x32x16_bf16 v[64:79], v[200:203], v[208:211], v[64:79]
    ds_read_b64_tr_b16 v[146:147], v20 offset:13312
    ds_read_b128 v[152:155], v25 offset:16384
    ds_read_b128 v[156:159], v25 offset:20480
    v_mfma_f32_32x32x16_bf16 v[80:95], v[200:203], v[212:215], v[80:95]
    ds_read_b64_tr_b16 v[148:149], v21 offset:12288
    ds_read_b64_tr_b16 v[150:151], v21 offset:13312
    buffer_load_dwordx4 v14, s[20:23], s57 offen offset:2048 lds
    v_mfma_f32_32x32x16_bf16 v[96:111], v[204:207], v[208:211], v[96:111]
    v_mfma_f32_32x32x16_bf16 v[112:127], v[204:207], v[212:215], v[112:127]
    buffer_load_dwordx4 v15, s[20:23], s57 offen offset:3072 lds
    s_add_u32 s57, s57, 229376
    s_cmp_eq_u32 s57, s97
    s_cselect_b32 s57, s95, s57
    s_waitcnt lgkmcnt(6)
    v_mfma_f32_16x16x32_bf16 v[160:163], v[128:131], v[164:167], v[160:163]
    v_mfma_f32_32x32x16_bf16 v[64:79], v[128:131], v[136:139], v[64:79]
    s_waitcnt lgkmcnt(0)
    s_waitcnt vmcnt(8)
    s_barrier
    ds_read_b64_tr_b16 v[200:201], v20 offset:16384
    ds_read_b64_tr_b16 v[202:203], v20 offset:17408
    v_mfma_f32_32x32x16_bf16 v[80:95], v[128:131], v[140:143], v[80:95]
    ds_read_b128 v[208:211], v22 offset:32768
    ds_read_b128 v[212:215], v22 offset:36864
    ds_read_b64_tr_b16 v[204:205], v21 offset:16384
    ds_read_b64_tr_b16 v[206:207], v21 offset:17408
    s_add_u32 m0, s72, 0
    v_nop_e64
    buffer_load_dwordx4 v8, s[8:11], s56 offen offset:0 lds
    v_mfma_f32_32x32x16_bf16 v[96:111], v[132:135], v[136:139], v[96:111]
    v_mov_b32 v2, s47
    v_mov_b32 v3, s47
    s_mov_b64 exec, 0xffff
    buffer_store_dwordx2 v[2:3], v46, s[32:35], s79 offen sc1
    s_mov_b64 exec, -1
    v_mfma_f32_32x32x16_bf16 v[112:127], v[132:135], v[140:143], v[112:127]
    buffer_load_dwordx4 v9, s[8:11], s56 offen offset:1024 lds
    v_mfma_f32_16x16x32_bf16 v[160:163], v[144:147], v[164:167], v[160:163]
    ds_read_b64_tr_b16 v[128:129], v20 offset:20480
    v_mfma_f32_32x32x16_bf16 v[64:79], v[144:147], v[152:155], v[64:79]
    ds_read_b64_tr_b16 v[130:131], v20 offset:21504
    ds_read_b128 v[136:139], v23 offset:32768
    ds_read_b128 v[140:143], v23 offset:36864
    v_mfma_f32_32x32x16_bf16 v[80:95], v[144:147], v[156:159], v[80:95]
    ds_read_b64_tr_b16 v[132:133], v21 offset:20480
    ds_read_b64_tr_b16 v[134:135], v21 offset:21504
    buffer_load_dwordx4 v10, s[8:11], s56 offen offset:2048 lds
    v_mfma_f32_32x32x16_bf16 v[96:111], v[148:151], v[152:155], v[96:111]
    v_mfma_f32_32x32x16_bf16 v[112:127], v[148:151], v[156:159], v[112:127]
    buffer_load_dwordx4 v11, s[8:11], s56 offen offset:3072 lds
    s_add_u32 s56, s56, 128
    s_cmp_eq_u32 s56, s96
    s_cselect_b32 s56, s93, s56
    s_waitcnt lgkmcnt(6)
    v_mfma_f32_16x16x32_bf16 v[160:163], v[200:203], v[164:167], v[160:163]
    ds_read_b64_tr_b16 v[144:145], v20 offset:24576
    v_mfma_f32_32x32x16_bf16 v[64:79], v[200:203], v[208:211], v[64:79]
    ds_read_b64_tr_b16 v[146:147], v20 offset:25600
    ds_read_b128 v[152:155], v24 offset:32768
    ds_read_b128 v[156:159], v24 offset:36864
    v_mfma_f32_32x32x16_bf16 v[80:95], v[200:203], v[212:215], v[80:95]
    ds_read_b64_tr_b16 v[148:149], v21 offset:24576
    ds_read_b64_tr_b16 v[150:151], v21 offset:25600
    s_add_u32 m0, s72, 65536
    v_nop_e64
    buffer_load_dwordx4 v12, s[20:23], s57 offen offset:0 lds
    v_mfma_f32_32x32x16_bf16 v[96:111], v[204:207], v[208:211], v[96:111]
    v_mfma_f32_32x32x16_bf16 v[112:127], v[204:207], v[212:215], v[112:127]
    buffer_load_dwordx4 v13, s[20:23], s57 offen offset:1024 lds
    s_waitcnt lgkmcnt(6)
    v_mfma_f32_16x16x32_bf16 v[160:163], v[128:131], v[164:167], v[160:163]
    ds_read_b64_tr_b16 v[200:201], v20 offset:28672
    v_mfma_f32_32x32x16_bf16 v[64:79], v[128:131], v[136:139], v[64:79]
    ds_read_b64_tr_b16 v[202:203], v20 offset:29696
    ds_read_b128 v[208:211], v25 offset:32768
    ds_read_b128 v[212:215], v25 offset:36864
    v_mfma_f32_32x32x16_bf16 v[80:95], v[128:131], v[140:143], v[80:95]
    ds_read_b64_tr_b16 v[204:205], v21 offset:28672
    ds_read_b64_tr_b16 v[206:207], v21 offset:29696
    buffer_load_dwordx4 v14, s[20:23], s57 offen offset:2048 lds
    v_mfma_f32_32x32x16_bf16 v[96:111], v[132:135], v[136:139], v[96:111]
    v_mfma_f32_32x32x16_bf16 v[112:127], v[132:135], v[140:143], v[112:127]
    buffer_load_dwordx4 v15, s[20:23], s57 offen offset:3072 lds
    s_add_u32 s57, s57, 229376
    s_cmp_eq_u32 s57, s97
    s_cselect_b32 s57, s95, s57
    s_waitcnt lgkmcnt(6)
    v_mfma_f32_16x16x32_bf16 v[160:163], v[144:147], v[164:167], v[160:163]
    v_mfma_f32_32x32x16_bf16 v[64:79], v[144:147], v[152:155], v[64:79]
    s_waitcnt lgkmcnt(0)
    s_waitcnt vmcnt(9)
    s_barrier
    ds_read_b64_tr_b16 v[128:129], v20 offset:32768
    ds_read_b64_tr_b16 v[130:131], v20 offset:33792
    s_add_u32 m0, s72, 16384
    s_nop 0
    buffer_load_dwordx4 v8, s[8:11], s56 offen offset:0 lds
    v_mfma_f32_32x32x16_bf16 v[80:95], v[144:147], v[156:159], v[80:95]
    ds_read_b128 v[136:139], v22 offset:49152
    ds_read_b128 v[140:143], v22 offset:53248
    ds_read_b64_tr_b16 v[132:133], v21 offset:32768
    ds_read_b64_tr_b16 v[134:135], v21 offset:33792
    v_mfma_f32_32x32x16_bf16 v[96:111], v[148:151], v[152:155], v[96:111]
    buffer_load_dwordx4 v9, s[8:11], s56 offen offset:1024 lds
    v_mfma_f32_32x32x16_bf16 v[112:127], v[148:151], v[156:159], v[112:127]
    v_mfma_f32_16x16x32_bf16 v[160:163], v[200:203], v[164:167], v[160:163]
    ds_read_b64_tr_b16 v[144:145], v20 offset:36864
    v_mfma_f32_32x32x16_bf16 v[64:79], v[200:203], v[208:211], v[64:79]
    ds_read_b64_tr_b16 v[146:147], v20 offset:37888
    ds_read_b128 v[152:155], v23 offset:49152
    ds_read_b128 v[156:159], v23 offset:53248
    buffer_load_dwordx4 v10, s[8:11], s56 offen offset:2048 lds
    v_mfma_f32_32x32x16_bf16 v[80:95], v[200:203], v[212:215], v[80:95]
    ds_read_b64_tr_b16 v[148:149], v21 offset:36864
    ds_read_b64_tr_b16 v[150:151], v21 offset:37888
    v_mfma_f32_32x32x16_bf16 v[96:111], v[204:207], v[208:211], v[96:111]
    buffer_load_dwordx4 v11, s[8:11], s56 offen offset:3072 lds
    s_add_u32 s56, s56, 128
    s_cmp_eq_u32 s56, s96
    s_cselect_b32 s56, s93, s56
    v_mfma_f32_32x32x16_bf16 v[112:127], v[204:207], v[212:215], v[112:127]
    s_waitcnt lgkmcnt(6)
    v_mfma_f32_16x16x32_bf16 v[160:163], v[128:131], v[164:167], v[160:163]
    ds_read_b64_tr_b16 v[200:201], v20 offset:40960
    v_mfma_f32_32x32x16_bf16 v[64:79], v[128:131], v[136:139], v[64:79]
    ds_read_b64_tr_b16 v[202:203], v20 offset:41984
    ds_read_b128 v[208:211], v24 offset:49152
    ds_read_b128 v[212:215], v24 offset:53248
    s_add_u32 m0, s72, 81920
    s_nop 0
    buffer_load_dwordx4 v12, s[20:23], s57 offen offset:0 lds
    v_mfma_f32_32x32x16_bf16 v[80:95], v[128:131], v[140:143], v[80:95]
    ds_read_b64_tr_b16 v[204:205], v21 offset:40960
    ds_read_b64_tr_b16 v[206:207], v21 offset:41984
    v_mfma_f32_32x32x16_bf16 v[96:111], v[132:135], v[136:139], v[96:111]
    buffer_load_dwordx4 v13, s[20:23], s57 offen offset:1024 lds
    v_mfma_f32_32x32x16_bf16 v[112:127], v[132:135], v[140:143], v[112:127]
    s_waitcnt lgkmcnt(6)
    v_mfma_f32_16x16x32_bf16 v[160:163], v[144:147], v[164:167], v[160:163]
    ds_read_b64_tr_b16 v[128:129], v20 offset:45056
    v_mfma_f32_32x32x16_bf16 v[64:79], v[144:147], v[152:155], v[64:79]
    ds_read_b64_tr_b16 v[130:131], v20 offset:46080
    ds_read_b128 v[136:139], v25 offset:49152
    ds_read_b128 v[140:143], v25 offset:53248
    buffer_load_dwordx4 v14, s[20:23], s57 offen offset:2048 lds
    v_mfma_f32_32x32x16_bf16 v[80:95], v[144:147], v[156:159], v[80:95]
    ds_read_b64_tr_b16 v[132:133], v21 offset:45056
    ds_read_b64_tr_b16 v[134:135], v21 offset:46080
    v_mfma_f32_32x32x16_bf16 v[96:111], v[148:151], v[152:155], v[96:111]
    buffer_load_dwordx4 v15, s[20:23], s57 offen offset:3072 lds
    s_add_u32 s57, s57, 229376
    s_cmp_eq_u32 s57, s97
    s_cselect_b32 s57, s95, s57
    v_mfma_f32_32x32x16_bf16 v[112:127], v[148:151], v[156:159], v[112:127]
    s_waitcnt lgkmcnt(6)
    v_mfma_f32_16x16x32_bf16 v[160:163], v[200:203], v[164:167], v[160:163]
    v_mfma_f32_32x32x16_bf16 v[64:79], v[200:203], v[208:211], v[64:79]
    s_waitcnt lgkmcnt(0)
    s_waitcnt vmcnt(8)
    s_barrier
    ds_read_b64_tr_b16 v[144:145], v20 offset:0
    ds_read_b64_tr_b16 v[146:147], v20 offset:1024
    s_add_u32 m0, s72, 32768
    s_nop 0
    buffer_load_dwordx4 v8, s[8:11], s56 offen offset:0 lds
    v_mfma_f32_32x32x16_bf16 v[80:95], v[200:203], v[212:215], v[80:95]
    ds_read_b128 v[152:155], v22 offset:0
    ds_read_b128 v[156:159], v22 offset:4096
    ds_read_b64_tr_b16 v[148:149], v21 offset:0
    ds_read_b64_tr_b16 v[150:151], v21 offset:1024
    v_mfma_f32_32x32x16_bf16 v[96:111], v[204:207], v[208:211], v[96:111]
    buffer_load_dwordx4 v9, s[8:11], s56 offen offset:1024 lds
    v_mfma_f32_32x32x16_bf16 v[112:127], v[204:207], v[212:215], v[112:127]
    v_mfma_f32_16x16x32_bf16 v[160:163], v[128:131], v[164:167], v[160:163]
    ds_read_b64_tr_b16 v[200:201], v20 offset:4096
    v_mfma_f32_32x32x16_bf16 v[64:79], v[128:131], v[136:139], v[64:79]
    ds_read_b64_tr_b16 v[202:203], v20 offset:5120
    ds_read_b128 v[208:211], v23 offset:0
    ds_read_b128 v[212:215], v23 offset:4096
    buffer_load_dwordx4 v10, s[8:11], s56 offen offset:2048 lds
    v_mfma_f32_32x32x16_bf16 v[80:95], v[128:131], v[140:143], v[80:95]
    ds_read_b64_tr_b16 v[204:205], v21 offset:4096
    ds_read_b64_tr_b16 v[206:207], v21 offset:5120
    v_mfma_f32_32x32x16_bf16 v[96:111], v[132:135], v[136:139], v[96:111]
    buffer_load_dwordx4 v11, s[8:11], s56 offen offset:3072 lds
    v_mfma_f32_32x32x16_bf16 v[112:127], v[132:135], v[140:143], v[112:127]
    s_add_u32 m0, s72, 98304
    s_nop 0
    buffer_load_dwordx4 v12, s[20:23], s57 offen offset:0 lds
    s_waitcnt lgkmcnt(6)
    v_mfma_f32_16x16x32_bf16 v[160:163], v[144:147], v[164:167], v[160:163]
    ds_read_b64_tr_b16 v[128:129], v20 offset:8192
    v_mfma_f32_32x32x16_bf16 v[64:79], v[144:147], v[152:155], v[64:79]
    ds_read_b64_tr_b16 v[130:131], v20 offset:9216
    ds_read_b128 v[136:139], v24 offset:0
    ds_read_b128 v[140:143], v24 offset:4096
    v_mfma_f32_32x32x16_bf16 v[80:95], v[144:147], v[156:159], v[80:95]
    ds_read_b64_tr_b16 v[132:133], v21 offset:8192
    ds_read_b64_tr_b16 v[134:135], v21 offset:9216
    buffer_load_dwordx4 v13, s[20:23], s57 offen offset:1024 lds
    v_mfma_f32_32x32x16_bf16 v[96:111], v[148:151], v[152:155], v[96:111]
    v_mfma_f32_32x32x16_bf16 v[112:127], v[148:151], v[156:159], v[112:127]
    buffer_load_dwordx4 v14, s[20:23], s57 offen offset:2048 lds
    s_waitcnt lgkmcnt(6)
    v_mfma_f32_16x16x32_bf16 v[160:163], v[200:203], v[164:167], v[160:163]
    ds_read_b64_tr_b16 v[144:145], v20 offset:12288
    v_mfma_f32_32x32x16_bf16 v[64:79], v[200:203], v[208:211], v[64:79]
    ds_read_b64_tr_b16 v[146:147], v20 offset:13312
    ds_read_b128 v[152:155], v25 offset:0
    ds_read_b128 v[156:159], v25 offset:4096
    v_mfma_f32_32x32x16_bf16 v[80:95], v[200:203], v[212:215], v[80:95]
    ds_read_b64_tr_b16 v[148:149], v21 offset:12288
    ds_read_b64_tr_b16 v[150:151], v21 offset:13312
    buffer_load_dwordx4 v15, s[20:23], s57 offen offset:3072 lds
    v_mfma_f32_32x32x16_bf16 v[96:111], v[204:207], v[208:211], v[96:111]
    v_mov_b32 v13, v48
    v_mov_b32 v12, v46
    v_mov_b32 v8, v192
    v_mov_b32 v9, v193
    v_mov_b32 v10, v194
    v_mov_b32_e64 v11, v195
    v_mfma_f32_32x32x16_bf16 v[112:127], v[204:207], v[212:215], v[112:127]
    buffer_load_dwordx2 v[250:251], v46, s[32:35], s55 offen sc1
    s_waitcnt lgkmcnt(6)
    v_mfma_f32_16x16x32_bf16 v[160:163], v[128:131], v[164:167], v[160:163]
    v_mfma_f32_32x32x16_bf16 v[64:79], v[128:131], v[136:139], v[64:79]
    s_waitcnt lgkmcnt(0)
    s_waitcnt vmcnt(9)
    s_barrier
    ds_read_b64_tr_b16 v[200:201], v20 offset:16384
    ds_read_b64_tr_b16 v[202:203], v20 offset:17408
    v_mfma_f32_32x32x16_bf16 v[80:95], v[128:131], v[140:143], v[80:95]
    ds_read_b128 v[208:211], v22 offset:16384
    ds_read_b128 v[212:215], v22 offset:20480
    ds_read_b64_tr_b16 v[204:205], v21 offset:16384
    ds_read_b64_tr_b16 v[206:207], v21 offset:17408
    buffer_load_dwordx2 v[32:33], v46, s[32:35], s55 offen offset:256 sc1
    v_mfma_f32_32x32x16_bf16 v[96:111], v[132:135], v[136:139], v[96:111]
    v_mfma_f32_32x32x16_bf16 v[112:127], v[132:135], v[140:143], v[112:127]
    v_mov_b32_e64 v14, s47
    s_mov_b32 exec_hi, 0
    buffer_load_dword v14, v13, s[32:35], s48 offen sc1
    s_mov_b64 exec, -1
    v_mfma_f32_16x16x32_bf16 v[160:163], v[144:147], v[164:167], v[160:163]
    ds_read_b64_tr_b16 v[128:129], v20 offset:20480
    v_mfma_f32_32x32x16_bf16 v[64:79], v[144:147], v[152:155], v[64:79]
    ds_read_b64_tr_b16 v[130:131], v20 offset:21504
    ds_read_b128 v[136:139], v23 offset:16384
    ds_read_b128 v[140:143], v23 offset:20480
    v_mfma_f32_32x32x16_bf16 v[80:95], v[144:147], v[156:159], v[80:95]
    ds_read_b64_tr_b16 v[132:133], v21 offset:20480
    ds_read_b64_tr_b16 v[134:135], v21 offset:21504
    s_add_u32 m0, s72, 49152
    v_nop_e64
    buffer_load_dwordx4 v16, s[24:27], s58 offen offset:0 lds
    v_mfma_f32_32x32x16_bf16 v[96:111], v[148:151], v[152:155], v[96:111]
    v_mfma_f32_32x32x16_bf16 v[112:127], v[148:151], v[156:159], v[112:127]
    buffer_load_dwordx4 v17, s[24:27], s58 offen offset:1024 lds
    s_waitcnt lgkmcnt(6)
    v_mfma_f32_16x16x32_bf16 v[160:163], v[200:203], v[164:167], v[160:163]
    ds_read_b64_tr_b16 v[144:145], v20 offset:24576
    v_mfma_f32_32x32x16_bf16 v[64:79], v[200:203], v[208:211], v[64:79]
    ds_read_b64_tr_b16 v[146:147], v20 offset:25600
    ds_read_b128 v[152:155], v24 offset:16384
    ds_read_b128 v[156:159], v24 offset:20480
    v_mfma_f32_32x32x16_bf16 v[80:95], v[200:203], v[212:215], v[80:95]
    ds_read_b64_tr_b16 v[148:149], v21 offset:24576
    ds_read_b64_tr_b16 v[150:151], v21 offset:25600
    buffer_load_dwordx4 v18, s[24:27], s58 offen offset:2048 lds
    v_mfma_f32_32x32x16_bf16 v[96:111], v[204:207], v[208:211], v[96:111]
    v_mfma_f32_32x32x16_bf16 v[112:127], v[204:207], v[212:215], v[112:127]
    buffer_load_dwordx4 v19, s[24:27], s58 offen offset:3072 lds
    s_add_u32 s58, s58, 28672
    s_waitcnt lgkmcnt(6)
    v_mfma_f32_16x16x32_bf16 v[160:163], v[128:131], v[164:167], v[160:163]
    ds_read_b64_tr_b16 v[200:201], v20 offset:28672
    v_mfma_f32_32x32x16_bf16 v[64:79], v[128:131], v[136:139], v[64:79]
    ds_read_b64_tr_b16 v[202:203], v20 offset:29696
    ds_read_b128 v[208:211], v25 offset:16384
    ds_read_b128 v[212:215], v25 offset:20480
    v_mfma_f32_32x32x16_bf16 v[80:95], v[128:131], v[140:143], v[80:95]
    ds_read_b64_tr_b16 v[204:205], v21 offset:28672
    ds_read_b64_tr_b16 v[206:207], v21 offset:29696
    s_add_u32 m0, s72, 0
    s_nop 0
    buffer_load_dwordx4 v16, s[24:27], s58 offen offset:0 lds
    v_mfma_f32_32x32x16_bf16 v[96:111], v[132:135], v[136:139], v[96:111]
    buffer_load_dwordx4 v17, s[24:27], s58 offen offset:1024 lds
    v_mfma_f32_32x32x16_bf16 v[112:127], v[132:135], v[140:143], v[112:127]
    s_waitcnt lgkmcnt(6)
    v_mfma_f32_16x16x32_bf16 v[160:163], v[144:147], v[164:167], v[160:163]
    v_mfma_f32_32x32x16_bf16 v[64:79], v[144:147], v[152:155], v[64:79]
    s_waitcnt lgkmcnt(0)
    s_waitcnt vmcnt(9)
    s_barrier
    ds_read_b64_tr_b16 v[128:129], v20 offset:32768
    ds_read_b64_tr_b16 v[130:131], v20 offset:33792
    buffer_load_dwordx4 v18, s[24:27], s58 offen offset:2048 lds
    v_mfma_f32_32x32x16_bf16 v[80:95], v[144:147], v[156:159], v[80:95]
    ds_read_b128 v[136:139], v22 offset:32768
    ds_read_b128 v[140:143], v22 offset:36864
    ds_read_b64_tr_b16 v[132:133], v21 offset:32768
    ds_read_b64_tr_b16 v[134:135], v21 offset:33792
    v_mfma_f32_32x32x16_bf16 v[96:111], v[148:151], v[152:155], v[96:111]
    buffer_load_dwordx4 v19, s[24:27], s58 offen offset:3072 lds
    s_add_u32 s58, s58, 28672
    v_mfma_f32_32x32x16_bf16 v[112:127], v[148:151], v[156:159], v[112:127]
    v_mfma_f32_16x16x32_bf16 v[160:163], v[200:203], v[164:167], v[160:163]
    ds_read_b64_tr_b16 v[144:145], v20 offset:36864
    v_mfma_f32_32x32x16_bf16 v[64:79], v[200:203], v[208:211], v[64:79]
    ds_read_b64_tr_b16 v[146:147], v20 offset:37888
    ds_read_b128 v[152:155], v23 offset:32768
    ds_read_b128 v[156:159], v23 offset:36864
    s_add_u32 m0, s72, 65536
    v_nop_e64
    buffer_load_dwordx4 v16, s[24:27], s58 offen offset:0 lds
    v_mfma_f32_32x32x16_bf16 v[80:95], v[200:203], v[212:215], v[80:95]
    ds_read_b64_tr_b16 v[148:149], v21 offset:36864
    ds_read_b64_tr_b16 v[150:151], v21 offset:37888
    v_mfma_f32_32x32x16_bf16 v[96:111], v[204:207], v[208:211], v[96:111]
    ds_read_b64_tr_b16 v[168:169], v20 offset:40960
    ds_read_b64_tr_b16 v[170:171], v20 offset:41984
    ds_read_b64_tr_b16 v[172:173], v20 offset:45056
    ds_read_b64_tr_b16 v[174:175], v20 offset:46080
    buffer_load_dwordx4 v17, s[24:27], s58 offen offset:1024 lds
    v_mfma_f32_32x32x16_bf16 v[112:127], v[204:207], v[212:215], v[112:127]
    s_waitcnt vmcnt(11)
    v_cmp_ne_u32 vcc, s47, v251
    v_nop_e64
    s_nop 0
    s_cbranch_vccz L_ok_1
    s_mov_b32 s71, 0
L_poll_2:
    buffer_load_dwordx2 v[250:251], v12, s[32:35], s55 offen sc1
    s_waitcnt vmcnt(0)
    v_cmp_ne_u32_e64 vcc, s47, v251
    s_add_u32 s71, s71, 1
    s_cmp_gt_u32 s71, 0x40000
    s_cbranch_vccz L_polld_3
    s_cbranch_scc0 L_poll_2
L_polld_3:
L_ok_1:
    s_waitcnt lgkmcnt(10)
    v_mfma_f32_16x16x32_bf16 v[160:163], v[128:131], v[164:167], v[160:163]
    ds_read_b64_tr_b16 v[200:201], v20 offset:40960
    v_mfma_f32_32x32x16_bf16 v[64:79], v[128:131], v[136:139], v[64:79]
    ds_read_b64_tr_b16 v[202:203], v20 offset:41984
    ds_read_b128 v[208:211], v24 offset:32768
    ds_read_b128 v[212:215], v24 offset:36864
    buffer_load_dwordx4 v18, s[24:27], s58 offen offset:2048 lds
    v_mfma_f32_32x32x16_bf16 v[80:95], v[128:131], v[140:143], v[80:95]
    ds_read_b64_tr_b16 v[204:205], v21 offset:40960
    ds_read_b64_tr_b16 v[206:207], v21 offset:41984
    s_waitcnt lgkmcnt(6)
    v_mfma_f32_16x16x32_bf16 v[160:163], v[144:147], v[164:167], v[160:163]
    v_mfma_f32_32x32x16_bf16 v[96:111], v[132:135], v[136:139], v[96:111]
    buffer_load_dwordx4 v19, s[24:27], s58 offen offset:3072 lds
    s_add_u32 s58, s58, 28672
    s_waitcnt vmcnt(12)
    v_cmp_ne_u32 vcc, s47, v14
    s_mov_b32 s51, 0
    v_nop_e64
    s_cbranch_vccnz L_nou_4
    s_mov_b32 s71, m0
    s_mov_b32 m0, s62
    s_mov_b32 s51, 1
    buffer_load_dwordx4 v28, s[32:35], s60 offen offset:0 sc1 lds
    buffer_load_dwordx4 v28, s[32:35], s60 offen offset:1024 sc1 lds
    s_mov_b32 m0, s71
    s_mov_b32 s71, 0
L_nou_4:
    v_mfma_f32_16x16x32_bf16 v[160:163], v[168:171], v[164:167], v[160:163]
    v_mfma_f32_32x32x16_bf16 v[112:127], v[132:135], v[140:143], v[112:127]
    v_mfma_f32_16x16x32_bf16 v[160:163], v[172:175], v[164:167], v[160:163]
    v_mfma_f32_32x32x16_bf16 v[64:79], v[144:147], v[152:155], v[64:79]
    ds_read_b64_tr_b16 v[128:129], v20 offset:45056
    ds_read_b64_tr_b16 v[130:131], v20 offset:46080
    ds_read_b128 v[136:139], v25 offset:32768
    s_add_u32 m0, s72, 16384
    v_nop_e64
    buffer_load_dwordx4 v16, s[24:27], s58 offen offset:0 lds
    v_mfma_f32_32x32x16_bf16 v[80:95], v[144:147], v[156:159], v[80:95]
    ds_read_b128 v[140:143], v25 offset:36864
    ds_read_b64_tr_b16 v[132:133], v21 offset:45056
    ds_read_b64_tr_b16 v[134:135], v21 offset:46080
    v_cmp_ne_u32 vcc, s47, v33
    s_nop 0
    s_nop 0
    s_cbranch_vccz L_ok_5
    s_mov_b32 s71, 0
L_poll_6:
    buffer_load_dwordx2 v[32:33], v12, s[32:35], s55 offen offset:256 sc1
    s_waitcnt vmcnt(0)
    v_cmp_ne_u32 vcc, s47, v33
    s_add_u32 s71, s71, 1
    s_cmp_gt_u32 s71, 0x40000
    s_cbranch_vccz L_polld_7
    s_cbranch_scc0 L_poll_6
L_polld_7:
L_ok_5:
    s_mov_b32 exec_lo, 0x00030003
    s_mov_b32 exec_hi, 0x00030003
    ds_write_b128 v252, v[160:163]
    s_mov_b64 exec, -1
    v_mfma_f32_32x32x16_bf16 v[96:111], v[148:151], v[152:155], v[96:111]
    buffer_load_dwordx4 v17, s[24:27], s58 offen offset:1024 lds
    s_mov_b32 s4, 0xbfb8aa3b
    v_lshlrev_b32 v224, 16, v250
    v_and_b32 v216, s74, v250
    v_rcp_f32 v220, v224
    v_xor_b32 v216, 0x80000000, v216
    v_mfma_f32_32x32x16_bf16 v[112:127], v[148:151], v[156:159], v[112:127]
    v_mul_f32 v220, s4, v220
    v_lshlrev_b32 v226, 16, v32
    v_and_b32 v218, s74, v32
    v_rcp_f32_e64 v222, v226
    v_xor_b32 v218, 0x80000000, v218
    s_waitcnt lgkmcnt(7)
    v_mfma_f32_32x32x16_bf16 v[64:79], v[200:203], v[208:211], v[64:79]
    s_waitcnt lgkmcnt(0)
    s_barrier
    ds_read_b128 v[168:171], v253 offset:0
    ds_read_b128 v[172:175], v253 offset:32
    ds_read_b128 v[176:179], v253 offset:64
    ds_read_b128 v[180:183], v253 offset:96
    buffer_load_dwordx4 v18, s[24:27], s58 offen offset:2048 lds
    v_mfma_f32_32x32x16_bf16 v[80:95], v[200:203], v[212:215], v[80:95]
    ds_read_b128 v[184:187], v254 offset:0
    ds_read_b128 v[188:191], v254 offset:32
    ds_read_b128 v[192:195], v254 offset:64
    ds_read_b128 v[196:199], v254 offset:96
    v_mul_f32_e64 v222, s4, v222
    v_mfma_f32_32x32x16_bf16 v[96:111], v[204:207], v[208:211], v[96:111]
    buffer_load_dwordx4 v19, s[24:27], s58 offen offset:3072 lds
    s_add_u32 s58, s58, 28672
    v_mfma_f32_32x32x16_bf16 v[112:127], v[204:207], v[212:215], v[112:127]
    v_mfma_f32_32x32x16_bf16 v[64:79], v[128:131], v[136:139], v[64:79]
    v_mfma_f32_32x32x16_bf16 v[80:95], v[128:131], v[140:143], v[80:95]
    v_mfma_f32_32x32x16_bf16 v[96:111], v[132:135], v[136:139], v[96:111]
    s_cmp_eq_u32 s51, 1
    s_cbranch_scc1 L_rp_8
    v_mov_b32_e64 v14, s47
    s_mov_b32 exec_hi, 0
    buffer_load_dword v14, v13, s[32:35], s48 offen sc1
    s_mov_b64 exec, -1
L_rp_8:
    v_mfma_f32_32x32x16_bf16 v[112:127], v[132:135], v[140:143], v[112:127]
    v_mov_b32 v20, v244
    v_mov_b32 v21, v245
    v_mov_b32 v22, v246
    v_mov_b32 v23, v247
    v_mov_b32 v24, v248
    v_mov_b32 v25, v249
    s_nop 1
    s_waitcnt lgkmcnt(4)
    v_pk_fma_f32 v[64:65], v[168:169], v[216:217], v[64:65] op_sel_hi:[1,0,1]
    v_pk_fma_f32 v[66:67], v[170:171], v[216:217], v[66:67] op_sel_hi:[1,0,1]
    v_pk_fma_f32 v[68:69], v[172:173], v[216:217], v[68:69] op_sel_hi:[1,0,1]
    v_pk_fma_f32 v[70:71], v[174:175], v[216:217], v[70:71] op_sel_hi:[1,0,1]
    v_pk_mul_f32 v[208:209], v[64:65], v[220:221] op_sel_hi:[1,0]
    s_add_u32 m0, s72, 81920
    v_nop_e64
    buffer_load_dwordx4 v16, s[24:27], s58 offen offset:0 lds
    v_pk_mul_f32 v[210:211], v[66:67], v[220:221] op_sel_hi:[1,0]
    v_pk_mul_f32 v[212:213], v[68:69], v[220:221] op_sel_hi:[1,0]
    v_pk_mul_f32 v[214:215], v[70:71], v[220:221] op_sel_hi:[1,0]
    buffer_load_dwordx4 v17, s[24:27], s58 offen offset:1024 lds
    v_exp_f32 v208, v208
    v_exp_f32 v209, v209
    v_exp_f32 v210, v210
    v_exp_f32 v211, v211
    buffer_load_dwordx4 v18, s[24:27], s58 offen offset:2048 lds
    v_exp_f32 v212, v212
    v_exp_f32 v213, v213
    v_exp_f32 v214, v214
    v_exp_f32 v215, v215
    buffer_load_dwordx4 v19, s[24:27], s58 offen offset:3072 lds
    s_add_u32 s58, s58, 28672
    v_pk_fma_f32 v[208:209], v[208:209], v[224:225], v[224:225] op_sel_hi:[1,0,0]
    v_pk_fma_f32 v[210:211], v[210:211], v[224:225], v[224:225] op_sel_hi:[1,0,0]
    v_pk_fma_f32 v[212:213], v[212:213], v[224:225], v[224:225] op_sel_hi:[1,0,0]
    v_pk_fma_f32 v[214:215], v[214:215], v[224:225], v[224:225] op_sel_hi:[1,0,0]
    s_add_u32 m0, s72, 32768
    s_nop 0
    buffer_load_dwordx4 v16, s[24:27], s58 offen offset:0 lds
    v_rcp_f32 v208, v208
    v_rcp_f32 v209, v209
    v_rcp_f32 v210, v210
    buffer_load_dwordx4 v17, s[24:27], s58 offen offset:1024 lds
    v_rcp_f32 v211, v211
    v_rcp_f32 v212, v212
    v_rcp_f32 v213, v213
    v_rcp_f32 v214, v214
    buffer_load_dwordx4 v18, s[24:27], s58 offen offset:2048 lds
    v_rcp_f32_e64 v215, v215
    v_pk_mul_f32 v[64:65], v[64:65], v[208:209]
    v_pk_mul_f32 v[66:67], v[66:67], v[210:211]
    v_pk_mul_f32 v[68:69], v[68:69], v[212:213]
    buffer_load_dwordx4 v19, s[24:27], s58 offen offset:3072 lds
    s_add_u32 s58, s58, 28672
    v_pk_mul_f32 v[70:71], v[70:71], v[214:215]
    v_cvt_pk_bf16_f32 v32, v64, v65
    v_cvt_pk_bf16_f32 v33, v66, v67
    v_cvt_pk_bf16_f32 v34, v68, v69
    v_cvt_pk_bf16_f32 v35, v70, v71
    buffer_store_dwordx4 v[32:35], v28, s[32:35], s67 offen offset:0 sc1
    v_pk_fma_f32 v[72:73], v[176:177], v[216:217], v[72:73] op_sel_hi:[1,0,1]
    v_pk_fma_f32 v[74:75], v[178:179], v[216:217], v[74:75] op_sel_hi:[1,0,1]
    v_pk_fma_f32 v[76:77], v[180:181], v[216:217], v[76:77] op_sel_hi:[1,0,1]
    v_pk_fma_f32 v[78:79], v[182:183], v[216:217], v[78:79] op_sel_hi:[1,0,1]
    v_pk_mul_f32 v[208:209], v[72:73], v[220:221] op_sel_hi:[1,0]
    v_pk_mul_f32 v[210:211], v[74:75], v[220:221] op_sel_hi:[1,0]
    v_pk_mul_f32 v[212:213], v[76:77], v[220:221] op_sel_hi:[1,0]
    v_pk_mul_f32 v[214:215], v[78:79], v[220:221] op_sel_hi:[1,0]
    v_exp_f32 v208, v208
    v_exp_f32 v209, v209
    v_exp_f32 v210, v210
    v_exp_f32 v211, v211
    v_exp_f32 v212, v212
    v_exp_f32 v213, v213
    v_exp_f32 v214, v214
    v_exp_f32 v215, v215
    v_pk_fma_f32 v[208:209], v[208:209], v[224:225], v[224:225] op_sel_hi:[1,0,0]
    v_pk_fma_f32 v[210:211], v[210:211], v[224:225], v[224:225] op_sel_hi:[1,0,0]
    v_pk_fma_f32 v[212:213], v[212:213], v[224:225], v[224:225] op_sel_hi:[1,0,0]
    v_pk_fma_f32 v[214:215], v[214:215], v[224:225], v[224:225] op_sel_hi:[1,0,0]
    v_rcp_f32 v208, v208
    v_rcp_f32 v209, v209
    v_rcp_f32 v210, v210
    v_rcp_f32 v211, v211
    v_rcp_f32 v212, v212
    v_rcp_f32 v213, v213
    v_rcp_f32 v214, v214
    v_rcp_f32 v215, v215
    v_pk_mul_f32 v[72:73], v[72:73], v[208:209]
    v_pk_mul_f32 v[74:75], v[74:75], v[210:211]
    v_pk_mul_f32 v[76:77], v[76:77], v[212:213]
    v_pk_mul_f32 v[78:79], v[78:79], v[214:215]
    v_cvt_pk_bf16_f32 v36, v72, v73
    v_cvt_pk_bf16_f32 v37, v74, v75
    v_cvt_pk_bf16_f32 v38, v76, v77
    v_cvt_pk_bf16_f32 v39, v78, v79
    buffer_store_dwordx4 v[36:39], v28, s[32:35], s67 offen offset:1024 sc1
    v_pk_fma_f32 v[80:81], v[168:169], v[218:219], v[80:81] op_sel_hi:[1,0,1]
    v_pk_fma_f32 v[82:83], v[170:171], v[218:219], v[82:83] op_sel_hi:[1,0,1]
    v_pk_fma_f32 v[84:85], v[172:173], v[218:219], v[84:85] op_sel_hi:[1,0,1]
    v_pk_fma_f32 v[86:87], v[174:175], v[218:219], v[86:87] op_sel_hi:[1,0,1]
    v_pk_mul_f32 v[208:209], v[80:81], v[222:223] op_sel_hi:[1,0]
    v_pk_mul_f32 v[210:211], v[82:83], v[222:223] op_sel_hi:[1,0]
    v_pk_mul_f32 v[212:213], v[84:85], v[222:223] op_sel_hi:[1,0]
    v_pk_mul_f32 v[214:215], v[86:87], v[222:223] op_sel_hi:[1,0]
    v_exp_f32 v208, v208
    v_exp_f32 v209, v209
    v_exp_f32 v210, v210
    v_exp_f32 v211, v211
    v_exp_f32 v212, v212
    v_exp_f32 v213, v213
    v_exp_f32 v214, v214
    v_exp_f32 v215, v215
    v_pk_fma_f32 v[208:209], v[208:209], v[226:227], v[226:227] op_sel_hi:[1,0,0]
    v_pk_fma_f32 v[210:211], v[210:211], v[226:227], v[226:227] op_sel_hi:[1,0,0]
    v_pk_fma_f32 v[212:213], v[212:213], v[226:227], v[226:227] op_sel_hi:[1,0,0]
    v_pk_fma_f32 v[214:215], v[214:215], v[226:227], v[226:227] op_sel_hi:[1,0,0]
    v_rcp_f32 v208, v208
    v_rcp_f32 v209, v209
    v_rcp_f32 v210, v210
    v_rcp_f32 v211, v211
    v_rcp_f32 v212, v212
    v_rcp_f32 v213, v213
    v_rcp_f32 v214, v214
    v_rcp_f32 v215, v215
    v_pk_mul_f32 v[80:81], v[80:81], v[208:209]
    v_pk_mul_f32 v[82:83], v[82:83], v[210:211]
    v_pk_mul_f32 v[84:85], v[84:85], v[212:213]
    v_pk_mul_f32 v[86:87], v[86:87], v[214:215]
    v_cvt_pk_bf16_f32 v40, v80, v81
    v_cvt_pk_bf16_f32 v41, v82, v83
    v_cvt_pk_bf16_f32 v42, v84, v85
    v_cvt_pk_bf16_f32 v43, v86, v87
    buffer_store_dwordx4 v[40:43], v28, s[32:35], s68 offen offset:0 sc1
    v_pk_fma_f32 v[88:89], v[176:177], v[218:219], v[88:89] op_sel_hi:[1,0,1]
    v_pk_fma_f32 v[90:91], v[178:179], v[218:219], v[90:91] op_sel_hi:[1,0,1]
    v_pk_fma_f32 v[92:93], v[180:181], v[218:219], v[92:93] op_sel_hi:[1,0,1]
    v_pk_fma_f32 v[94:95], v[182:183], v[218:219], v[94:95] op_sel_hi:[1,0,1]
    v_pk_mul_f32 v[208:209], v[88:89], v[222:223] op_sel_hi:[1,0]
    v_pk_mul_f32 v[210:211], v[90:91], v[222:223] op_sel_hi:[1,0]
    v_pk_mul_f32 v[212:213], v[92:93], v[222:223] op_sel_hi:[1,0]
    v_pk_mul_f32 v[214:215], v[94:95], v[222:223] op_sel_hi:[1,0]
    v_exp_f32 v208, v208
    v_exp_f32 v209, v209
    v_exp_f32 v210, v210
    v_exp_f32 v211, v211
    v_exp_f32 v212, v212
    v_exp_f32 v213, v213
    v_exp_f32 v214, v214
    v_exp_f32 v215, v215
    v_pk_fma_f32 v[208:209], v[208:209], v[226:227], v[226:227] op_sel_hi:[1,0,0]
    v_pk_fma_f32 v[210:211], v[210:211], v[226:227], v[226:227] op_sel_hi:[1,0,0]
    v_pk_fma_f32 v[212:213], v[212:213], v[226:227], v[226:227] op_sel_hi:[1,0,0]
    v_pk_fma_f32 v[214:215], v[214:215], v[226:227], v[226:227] op_sel_hi:[1,0,0]
    v_rcp_f32 v208, v208
    v_rcp_f32 v209, v209
    v_rcp_f32 v210, v210
    v_rcp_f32 v211, v211
    v_rcp_f32 v212, v212
    v_rcp_f32 v213, v213
    v_rcp_f32 v214, v214
    v_rcp_f32 v215, v215
    v_pk_mul_f32 v[88:89], v[88:89], v[208:209]
    v_pk_mul_f32 v[90:91], v[90:91], v[210:211]
    s_cmp_eq_u32 s51, 1
    s_cbranch_scc1 L_nou2_9
    s_waitcnt vmcnt(11)
    v_cmp_ne_u32 vcc, s47, v14
    s_nop 1
    s_cbranch_vccnz L_nou2_9
    s_mov_b32 m0, s62
    s_mov_b32 s51, 1
    buffer_load_dwordx4 v28, s[32:35], s60 offen offset:0 sc1 lds
    buffer_load_dwordx4 v28, s[32:35], s60 offen offset:1024 sc1 lds
L_nou2_9:
    v_pk_mul_f32 v[92:93], v[92:93], v[212:213]
    v_pk_mul_f32 v[94:95], v[94:95], v[214:215]
    v_cvt_pk_bf16_f32 v44, v88, v89
    v_cvt_pk_bf16_f32 v45, v90, v91
    v_cvt_pk_bf16_f32 v46, v92, v93
    v_cvt_pk_bf16_f32 v47, v94, v95
    buffer_store_dwordx4 v[44:47], v28, s[32:35], s68 offen offset:1024 sc1
    s_waitcnt lgkmcnt(0)
    v_pk_fma_f32 v[96:97], v[184:185], v[216:217], v[96:97] op_sel_hi:[1,0,1]
    v_pk_fma_f32 v[98:99], v[186:187], v[216:217], v[98:99] op_sel_hi:[1,0,1]
    v_pk_fma_f32 v[100:101], v[188:189], v[216:217], v[100:101] op_sel_hi:[1,0,1]
    v_pk_fma_f32 v[102:103], v[190:191], v[216:217], v[102:103] op_sel_hi:[1,0,1]
    v_pk_mul_f32 v[208:209], v[96:97], v[220:221] op_sel_hi:[1,0]
    v_pk_mul_f32 v[210:211], v[98:99], v[220:221] op_sel_hi:[1,0]
    v_pk_mul_f32 v[212:213], v[100:101], v[220:221] op_sel_hi:[1,0]
    v_pk_mul_f32 v[214:215], v[102:103], v[220:221] op_sel_hi:[1,0]
    v_exp_f32 v208, v208
    v_exp_f32 v209, v209
    v_exp_f32 v210, v210
    v_exp_f32 v211, v211
    v_exp_f32 v212, v212
    v_exp_f32 v213, v213
    v_exp_f32 v214, v214
    v_exp_f32_e64 v215, v215
    v_pk_fma_f32 v[208:209], v[208:209], v[224:225], v[224:225] op_sel_hi:[1,0,0]
    v_pk_fma_f32 v[210:211], v[210:211], v[224:225], v[224:225] op_sel_hi:[1,0,0]
    v_pk_fma_f32 v[212:213], v[212:213], v[224:225], v[224:225] op_sel_hi:[1,0,0]
    v_pk_fma_f32 v[214:215], v[214:215], v[224:225], v[224:225] op_sel_hi:[1,0,0]
    v_rcp_f32 v208, v208
    v_rcp_f32 v209, v209
    v_rcp_f32 v210, v210
    v_rcp_f32 v211, v211
    v_rcp_f32 v212, v212
    v_rcp_f32 v213, v213
    v_rcp_f32 v214, v214
    v_rcp_f32 v215, v215
    v_pk_mul_f32 v[96:97], v[96:97], v[208:209]
    v_pk_mul_f32 v[98:99], v[98:99], v[210:211]
    v_pk_mul_f32 v[100:101], v[100:101], v[212:213]
    v_pk_mul_f32 v[102:103], v[102:103], v[214:215]
    v_cvt_pk_bf16_f32 v48, v96, v97
    v_cvt_pk_bf16_f32 v49, v98, v99
    v_cvt_pk_bf16_f32 v50, v100, v101
    v_cvt_pk_bf16_f32 v51, v102, v103
    buffer_store_dwordx4 v[48:51], v28, s[32:35], s69 offen offset:0 sc1
    v_pk_fma_f32 v[104:105], v[192:193], v[216:217], v[104:105] op_sel_hi:[1,0,1]
    v_pk_fma_f32 v[106:107], v[194:195], v[216:217], v[106:107] op_sel_hi:[1,0,1]
    v_pk_fma_f32 v[108:109], v[196:197], v[216:217], v[108:109] op_sel_hi:[1,0,1]
    v_pk_fma_f32 v[110:111], v[198:199], v[216:217], v[110:111] op_sel_hi:[1,0,1]
    v_pk_mul_f32 v[208:209], v[104:105], v[220:221] op_sel_hi:[1,0]
    v_pk_mul_f32 v[210:211], v[106:107], v[220:221] op_sel_hi:[1,0]
    v_pk_mul_f32 v[212:213], v[108:109], v[220:221] op_sel_hi:[1,0]
    v_pk_mul_f32 v[214:215], v[110:111], v[220:221] op_sel_hi:[1,0]
    v_exp_f32 v208, v208
    v_exp_f32 v209, v209
    v_exp_f32 v210, v210
    v_exp_f32 v211, v211
    v_exp_f32 v212, v212
    v_exp_f32 v213, v213
    v_exp_f32 v214, v214
    v_exp_f32 v215, v215
    v_pk_fma_f32 v[208:209], v[208:209], v[224:225], v[224:225] op_sel_hi:[1,0,0]
    v_pk_fma_f32 v[210:211], v[210:211], v[224:225], v[224:225] op_sel_hi:[1,0,0]
    v_pk_fma_f32 v[212:213], v[212:213], v[224:225], v[224:225] op_sel_hi:[1,0,0]
    v_pk_fma_f32 v[214:215], v[214:215], v[224:225], v[224:225] op_sel_hi:[1,0,0]
    v_rcp_f32 v208, v208
    v_rcp_f32 v209, v209
    v_rcp_f32 v210, v210
    v_rcp_f32 v211, v211
    v_rcp_f32 v212, v212
    v_rcp_f32 v213, v213
    v_rcp_f32 v214, v214
    v_rcp_f32 v215, v215
    v_pk_mul_f32 v[104:105], v[104:105], v[208:209]
    v_pk_mul_f32 v[106:107], v[106:107], v[210:211]
    v_pk_mul_f32 v[108:109], v[108:109], v[212:213]
    v_pk_mul_f32 v[110:111], v[110:111], v[214:215]
    v_cvt_pk_bf16_f32 v52, v104, v105
    v_cvt_pk_bf16_f32 v53, v106, v107
    v_cvt_pk_bf16_f32 v54, v108, v109
    v_cvt_pk_bf16_f32 v55, v110, v111
    buffer_store_dwordx4 v[52:55], v28, s[32:35], s69 offen offset:1024 sc1
    v_pk_fma_f32 v[112:113], v[184:185], v[218:219], v[112:113] op_sel_hi:[1,0,1]
    v_pk_fma_f32 v[114:115], v[186:187], v[218:219], v[114:115] op_sel_hi:[1,0,1]
    v_pk_fma_f32 v[116:117], v[188:189], v[218:219], v[116:117] op_sel_hi:[1,0,1]
    v_pk_fma_f32 v[118:119], v[190:191], v[218:219], v[118:119] op_sel_hi:[1,0,1]
    v_pk_mul_f32 v[208:209], v[112:113], v[222:223] op_sel_hi:[1,0]
    v_pk_mul_f32 v[210:211], v[114:115], v[222:223] op_sel_hi:[1,0]
    v_pk_mul_f32 v[212:213], v[116:117], v[222:223] op_sel_hi:[1,0]
    v_pk_mul_f32 v[214:215], v[118:119], v[222:223] op_sel_hi:[1,0]
    v_exp_f32 v208, v208
    v_exp_f32 v209, v209
    v_exp_f32 v210, v210
    v_exp_f32 v211, v211
    v_exp_f32 v212, v212
    v_exp_f32 v213, v213
    v_exp_f32 v214, v214
    v_exp_f32 v215, v215
    v_pk_fma_f32 v[208:209], v[208:209], v[226:227], v[226:227] op_sel_hi:[1,0,0]
    v_pk_fma_f32 v[210:211], v[210:211], v[226:227], v[226:227] op_sel_hi:[1,0,0]
    v_pk_fma_f32 v[212:213], v[212:213], v[226:227], v[226:227] op_sel_hi:[1,0,0]
    v_pk_fma_f32 v[214:215], v[214:215], v[226:227], v[226:227] op_sel_hi:[1,0,0]
    v_rcp_f32 v208, v208
    v_rcp_f32 v209, v209
    v_rcp_f32 v210, v210
    s_cmp_eq_u32 s51, 1
    s_cbranch_scc1 L_haveu_10
    s_mov_b32 s71, 0
L_poll_11:
    v_mov_b32 v14, s47
    s_mov_b32 exec_hi, 0
    buffer_load_dword v14, v13, s[32:35], s48 offen sc1
    s_mov_b64 exec, -1
    s_waitcnt vmcnt(0)
    v_cmp_ne_u32 vcc, s47, v14
    s_add_u32 s71, s71, 1
    s_cmp_gt_u32 s71, 0x40000
    s_cbranch_vccz L_polld_12
    s_cbranch_scc0 L_poll_11
L_polld_12:
    s_mov_b32 m0, s62
    s_mov_b32 s51, 1
    buffer_load_dwordx4 v28, s[32:35], s60 offen offset:0 sc1 lds
    buffer_load_dwordx4 v28, s[32:35], s60 offen offset:1024 sc1 lds
    s_waitcnt vmcnt(0)
L_haveu_10:
    s_waitcnt vmcnt(3)
    s_waitcnt lgkmcnt(0)
    s_barrier
    v_rcp_f32 v211, v211
    ds_read_b64_tr_b16 v[64:65], v29 offset:8
    v_rcp_f32 v212, v212
    v_rcp_f32 v213, v213
    ds_read_b64_tr_b16 v[66:67], v29 offset:0
    v_rcp_f32 v214, v214
    v_rcp_f32_e64 v215, v215
    ds_read_b128 v[128:131], v30 offset:192
    v_pk_mul_f32 v[112:113], v[112:113], v[208:209]
    v_pk_mul_f32 v[114:115], v[114:115], v[210:211]
    ds_read_b64_tr_b16 v[68:69], v29 offset:520
    v_pk_mul_f32 v[116:117], v[116:117], v[212:213]
    v_pk_mul_f32 v[118:119], v[118:119], v[214:215]
    ds_read_b64_tr_b16 v[70:71], v29 offset:512
    v_cvt_pk_bf16_f32 v56, v112, v113
    v_cvt_pk_bf16_f32 v57, v114, v115
    ds_read_b128 v[132:135], v30 offset:704
    v_cvt_pk_bf16_f32 v58, v116, v117
    v_cvt_pk_bf16_f32 v59, v118, v119
    ds_read_b64_tr_b16 v[72:73], v29 offset:1032
    buffer_store_dwordx4 v[56:59], v28, s[32:35], s70 offen offset:0 sc1
    v_pk_fma_f32 v[120:121], v[192:193], v[218:219], v[120:121] op_sel_hi:[1,0,1]
    ds_read_b64_tr_b16 v[74:75], v29 offset:1024
    v_pk_fma_f32 v[122:123], v[194:195], v[218:219], v[122:123] op_sel_hi:[1,0,1]
    v_pk_fma_f32 v[124:125], v[196:197], v[218:219], v[124:125] op_sel_hi:[1,0,1]
    ds_read_b128 v[136:139], v30 offset:1216
    v_pk_fma_f32 v[126:127], v[198:199], v[218:219], v[126:127] op_sel_hi:[1,0,1]
    v_pk_mul_f32 v[208:209], v[120:121], v[222:223] op_sel_hi:[1,0]
    ds_read_b64_tr_b16 v[76:77], v29 offset:1544
    v_pk_mul_f32 v[210:211], v[122:123], v[222:223] op_sel_hi:[1,0]
    v_pk_mul_f32 v[212:213], v[124:125], v[222:223] op_sel_hi:[1,0]
    ds_read_b64_tr_b16 v[78:79], v29 offset:1536
    v_pk_mul_f32 v[214:215], v[126:127], v[222:223] op_sel_hi:[1,0]
    v_exp_f32 v208, v208
    ds_read_b128 v[140:143], v30 offset:1728
    v_exp_f32 v209, v209
    v_exp_f32_e64 v210, v210
    ds_read_b64_tr_b16 v[80:81], v29 offset:2056
    v_exp_f32 v211, v211
    v_exp_f32 v212, v212
    ds_read_b64_tr_b16 v[82:83], v29 offset:2048
    v_exp_f32 v213, v213
    v_exp_f32 v214, v214
    ds_read_b128 v[144:147], v30 offset:2240
    v_exp_f32_e64 v215, v215
    v_pk_fma_f32 v[208:209], v[208:209], v[226:227], v[226:227] op_sel_hi:[1,0,0]
    ds_read_b64_tr_b16 v[84:85], v29 offset:2568
    v_pk_fma_f32 v[210:211], v[210:211], v[226:227], v[226:227] op_sel_hi:[1,0,0]
    v_pk_fma_f32 v[212:213], v[212:213], v[226:227], v[226:227] op_sel_hi:[1,0,0]
    ds_read_b64_tr_b16 v[86:87], v29 offset:2560
    v_pk_fma_f32 v[214:215], v[214:215], v[226:227], v[226:227] op_sel_hi:[1,0,0]
    v_rcp_f32 v208, v208
    ds_read_b128 v[148:151], v30 offset:2752
    v_rcp_f32 v209, v209
    v_rcp_f32 v210, v210
    ds_read_b64_tr_b16 v[88:89], v29 offset:3080
    v_rcp_f32 v211, v211
    v_rcp_f32 v212, v212
    ds_read_b64_tr_b16 v[90:91], v29 offset:3072
    v_rcp_f32 v213, v213
    v_rcp_f32 v214, v214
    ds_read_b128 v[152:155], v30 offset:3264
    v_rcp_f32 v215, v215
    v_pk_mul_f32 v[120:121], v[120:121], v[208:209]
    ds_read_b64_tr_b16 v[92:93], v29 offset:3592
    v_pk_mul_f32 v[122:123], v[122:123], v[210:211]
    v_pk_mul_f32 v[124:125], v[124:125], v[212:213]
    ds_read_b64_tr_b16 v[94:95], v29 offset:3584
    v_pk_mul_f32 v[126:127], v[126:127], v[214:215]
    v_cvt_pk_bf16_f32 v60, v120, v121
    ds_read_b128 v[156:159], v30 offset:3776
    v_cvt_pk_bf16_f32 v61, v122, v123
    v_cvt_pk_bf16_f32 v62, v124, v125
    v_cvt_pk_bf16_f32 v63, v126, v127
    buffer_store_dwordx4 v[60:63], v28, s[32:35], s70 offen offset:1024 sc1
    s_waitcnt lgkmcnt(15)
    v_mfma_f32_16x16x32_bf16 a[224:227], v[64:67], v[128:131], 0
    ds_read_b64_tr_b16 a[0:1], v26 offset:49152
    ds_read_b64_tr_b16 a[4:5], v27 offset:49152
    v_mfma_f32_16x16x32_bf16 a[228:231], v[64:67], v[132:135], 0
    ds_read_b64_tr_b16 v[96:97], v29 offset:72
    ds_read_b64_tr_b16 a[2:3], v26 offset:50176
    v_mfma_f32_16x16x32_bf16 a[232:235], v[68:71], v[132:135], 0
    ds_read_b64_tr_b16 v[98:99], v29 offset:64
    ds_read_b64_tr_b16 a[6:7], v27 offset:50176
    v_mfma_f32_16x16x32_bf16 a[228:231], v[68:71], v[128:131], a[228:231]
    ds_read_b128 v[160:163], v30 offset:128
    ds_read_b64_tr_b16 a[8:9], v26 offset:51200
    ds_read_b64_tr_b16 a[12:13], v27 offset:51200
    v_mfma_f32_16x16x32_bf16 a[232:235], v[64:67], v[136:139], a[232:235]
    ds_read_b64_tr_b16 a[10:11], v26 offset:52224
    v_mfma_f32_16x16x32_bf16 a[236:239], v[68:71], v[136:139], 0
    ds_read_b64_tr_b16 v[100:101], v29 offset:584
    ds_read_b64_tr_b16 a[14:15], v27 offset:52224
    v_mfma_f32_16x16x32_bf16 a[240:243], v[72:75], v[136:139], 0
    ds_read_b64_tr_b16 v[102:103], v29 offset:576
    v_mfma_f32_16x16x32_bf16 a[232:235], v[72:75], v[128:131], a[232:235]
    s_add_u32 m0, s72, 49152
    s_waitcnt lgkmcnt(1)
    buffer_load_dwordx4 v16, s[24:27], s58 offen offset:0 lds
    v_mfma_f32_16x16x32_bf16 a[236:239], v[72:75], v[132:135], a[236:239]
    ds_read_b128 v[164:167], v30 offset:640
    v_mfma_f32_16x16x32_bf16 a[236:239], v[64:67], v[140:143], a[236:239]
    ds_read_b64_tr_b16 v[104:105], v29 offset:1096
    v_mfma_f32_16x16x32_bf16 a[240:243], v[68:71], v[140:143], a[240:243]
    ds_read_b64_tr_b16 v[106:107], v29 offset:1088
    buffer_load_dwordx4 v17, s[24:27], s58 offen offset:1024 lds
    v_mfma_f32_16x16x32_bf16 a[244:247], v[72:75], v[140:143], 0
    v_mfma_f32_16x16x32_bf16 a[248:251], v[76:79], v[140:143], 0
    ds_read_b128 v[168:171], v30 offset:1152
    ds_read_b64_tr_b16 a[16:17], v26 offset:0
    ds_read_b64_tr_b16 a[20:21], v27 offset:0
    v_mfma_f32_16x16x32_bf16 a[236:239], v[76:79], v[128:131], a[236:239]
    ds_read_b64_tr_b16 v[108:109], v29 offset:1608
    buffer_load_dwordx4 v18, s[24:27], s58 offen offset:2048 lds
    ds_read_b64_tr_b16 a[18:19], v26 offset:1024
    v_mfma_f32_16x16x32_bf16 a[240:243], v[76:79], v[132:135], a[240:243]
    ds_read_b64_tr_b16 a[22:23], v27 offset:1024
    v_mfma_f32_16x16x32_bf16 a[244:247], v[76:79], v[136:139], a[244:247]
    ds_read_b64_tr_b16 v[110:111], v29 offset:1600
    ds_read_b64_tr_b16 a[24:25], v26 offset:2048
    ds_read_b64_tr_b16 a[28:29], v27 offset:2048
    v_mfma_f32_16x16x32_bf16 a[240:243], v[64:67], v[144:147], a[240:243]
    ds_read_b128 v[172:175], v30 offset:1664
    buffer_load_dwordx4 v19, s[24:27], s58 offen offset:3072 lds
    s_add_u32 s58, s58, 28672
    ds_read_b64_tr_b16 a[26:27], v26 offset:3072
    v_mfma_f32_16x16x32_bf16 a[244:247], v[68:71], v[144:147], a[244:247]
    ds_read_b64_tr_b16 a[30:31], v27 offset:3072
    v_mfma_f32_16x16x32_bf16 a[248:251], v[72:75], v[144:147], a[248:251]
    ds_read_b64_tr_b16 v[112:113], v29 offset:2120
    v_mfma_f32_16x16x32_bf16 a[252:255], v[76:79], v[144:147], 0
    ds_read_b64_tr_b16 v[114:115], v29 offset:2112
    s_add_u32 m0, s72, 0
    s_waitcnt lgkmcnt(2)
    buffer_load_dwordx4 v16, s[24:27], s58 offen offset:0 lds
    v_mfma_f32_16x16x32_bf16 a[240:243], v[80:83], v[128:131], a[240:243]
    ds_read_b128 v[176:179], v30 offset:2176
    v_mfma_f32_16x16x32_bf16 a[244:247], v[80:83], v[132:135], a[244:247]
    v_mfma_f32_16x16x32_bf16 a[248:251], v[80:83], v[136:139], a[248:251]
    ds_read_b64_tr_b16 v[116:117], v29 offset:2632
    buffer_load_dwordx4 v17, s[24:27], s58 offen offset:1024 lds
    s_waitcnt vmcnt(6)
    v_mfma_f32_16x16x32_bf16 a[252:255], v[80:83], v[140:143], a[252:255]
    ds_read_b64_tr_b16 v[118:119], v29 offset:2624
    v_mov_b32 v2, s47
    v_mov_b32_e64 v3, s47
    v_mfma_f32_16x16x32_bf16 a[244:247], v[64:67], v[148:151], a[244:247]
    ds_read_b64_tr_b16 a[32:33], v24 offset:0
    ds_read_b64_tr_b16 a[36:37], v25 offset:0
    s_mov_b64 exec, 0xffff
    buffer_store_dwordx2 v[2:3], v12, s[32:35], s80 offen sc1
    s_mov_b64 exec, -1
    v_mfma_f32_16x16x32_bf16 a[248:251], v[68:71], v[148:151], a[248:251]
    ds_read_b128 v[180:183], v30 offset:2688
    buffer_load_dwordx4 v18, s[24:27], s58 offen offset:2048 lds
    ds_read_b64_tr_b16 a[34:35], v24 offset:1024
    v_mfma_f32_16x16x32_bf16 a[252:255], v[72:75], v[148:151], a[252:255]
    ds_read_b64_tr_b16 v[120:121], v29 offset:3144
    ds_read_b64_tr_b16 a[38:39], v25 offset:1024
    v_mfma_f32_16x16x32_bf16 a[244:247], v[84:87], v[128:131], a[244:247]
    ds_read_b64_tr_b16 v[122:123], v29 offset:3136
    ds_read_b64_tr_b16 a[40:41], v24 offset:2048
    ds_read_b64_tr_b16 a[44:45], v25 offset:2048
    v_mfma_f32_16x16x32_bf16 a[248:251], v[84:87], v[132:135], a[248:251]
    buffer_load_dwordx4 v19, s[24:27], s58 offen offset:3072 lds
    s_add_u32 s58, s58, 28672
    ds_read_b64_tr_b16 a[42:43], v24 offset:3072
    v_mfma_f32_16x16x32_bf16 a[252:255], v[84:87], v[136:139], a[252:255]
    ds_read_b128 v[184:187], v30 offset:3200
    ds_read_b64_tr_b16 a[46:47], v25 offset:3072
    v_mfma_f32_16x16x32_bf16 a[248:251], v[64:67], v[152:155], a[248:251]
    ds_read_b64_tr_b16 v[124:125], v29 offset:3656
    v_mfma_f32_16x16x32_bf16 a[252:255], v[68:71], v[152:155], a[252:255]
    s_add_u32 m0, s72, 65536
    s_waitcnt lgkmcnt(1)
    buffer_load_dwordx4 v16, s[24:27], s58 offen offset:0 lds
    v_mfma_f32_16x16x32_bf16 a[248:251], v[88:91], v[128:131], a[248:251]
    ds_read_b64_tr_b16 v[126:127], v29 offset:3648
    v_mfma_f32_16x16x32_bf16 a[252:255], v[88:91], v[132:135], a[252:255]
    ds_read_b128 v[188:191], v30 offset:3712
    v_mfma_f32_16x16x32_bf16 a[252:255], v[64:67], v[156:159], a[252:255]
    buffer_load_dwordx4 v17, s[24:27], s58 offen offset:1024 lds
    v_mfma_f32_16x16x32_bf16 a[252:255], v[92:95], v[128:131], a[252:255]
    s_waitcnt lgkmcnt(0)
    v_mfma_f32_16x16x32_bf16 a[224:227], v[96:99], v[160:163], a[224:227]
    ds_read_b64_tr_b16 a[48:49], v26 offset:16384
    ds_read_b64_tr_b16 a[52:53], v27 offset:16384
    v_mfma_f32_16x16x32_bf16 a[228:231], v[96:99], v[164:167], a[228:231]
    ds_read_b64_tr_b16 v[64:65], v29 offset:136
    buffer_load_dwordx4 v18, s[24:27], s58 offen offset:2048 lds
    ds_read_b64_tr_b16 a[50:51], v26 offset:17408
    v_mfma_f32_16x16x32_bf16 a[232:235], v[100:103], v[164:167], a[232:235]
    ds_read_b64_tr_b16 v[66:67], v29 offset:128
    ds_read_b64_tr_b16 a[54:55], v27 offset:17408
    v_mfma_f32_16x16x32_bf16 a[228:231], v[100:103], v[160:163], a[228:231]
    ds_read_b128 v[128:131], v30 offset:64
    ds_read_b64_tr_b16 a[56:57], v26 offset:18432
    ds_read_b64_tr_b16 a[60:61], v27 offset:18432
    v_mfma_f32_16x16x32_bf16 a[232:235], v[96:99], v[168:171], a[232:235]
    buffer_load_dwordx4 v19, s[24:27], s58 offen offset:3072 lds
    s_add_u32 s58, s58, 28672
    ds_read_b64_tr_b16 a[58:59], v26 offset:19456
    v_mfma_f32_16x16x32_bf16 a[236:239], v[100:103], v[168:171], a[236:239]
    ds_read_b64_tr_b16 v[68:69], v29 offset:648
    ds_read_b64_tr_b16 a[62:63], v27 offset:19456
    v_mfma_f32_16x16x32_bf16 a[240:243], v[104:107], v[168:171], a[240:243]
    ds_read_b64_tr_b16 v[70:71], v29 offset:640
    v_mfma_f32_16x16x32_bf16 a[232:235], v[104:107], v[160:163], a[232:235]
    s_add_u32 m0, s72, 16384
    s_waitcnt lgkmcnt(1)
    buffer_load_dwordx4 v16, s[24:27], s58 offen offset:0 lds
    v_mfma_f32_16x16x32_bf16 a[236:239], v[104:107], v[164:167], a[236:239]
    ds_read_b128 v[132:135], v30 offset:576
    v_mfma_f32_16x16x32_bf16 a[236:239], v[96:99], v[172:175], a[236:239]
    ds_read_b64_tr_b16 v[72:73], v29 offset:1160
    v_mfma_f32_16x16x32_bf16 a[240:243], v[100:103], v[172:175], a[240:243]
    ds_read_b64_tr_b16 v[74:75], v29 offset:1152
    buffer_load_dwordx4 v17, s[24:27], s58 offen offset:1024 lds
    v_mfma_f32_16x16x32_bf16 a[244:247], v[104:107], v[172:175], a[244:247]
    v_mfma_f32_16x16x32_bf16 a[248:251], v[108:111], v[172:175], a[248:251]
    ds_read_b128 v[136:139], v30 offset:1088
    ds_read_b64_tr_b16 a[64:65], v24 offset:16384
    ds_read_b64_tr_b16 a[68:69], v25 offset:16384
    v_mfma_f32_16x16x32_bf16 a[236:239], v[108:111], v[160:163], a[236:239]
    ds_read_b64_tr_b16 v[76:77], v29 offset:1672
    buffer_load_dwordx4 v18, s[24:27], s58 offen offset:2048 lds
    ds_read_b64_tr_b16 a[66:67], v24 offset:17408
    v_mfma_f32_16x16x32_bf16 a[240:243], v[108:111], v[164:167], a[240:243]
    ds_read_b64_tr_b16 a[70:71], v25 offset:17408
    v_mfma_f32_16x16x32_bf16 a[244:247], v[108:111], v[168:171], a[244:247]
    ds_read_b64_tr_b16 v[78:79], v29 offset:1664
    ds_read_b64_tr_b16 a[72:73], v24 offset:18432
    ds_read_b64_tr_b16 a[76:77], v25 offset:18432
    v_mfma_f32_16x16x32_bf16 a[240:243], v[96:99], v[176:179], a[240:243]
    ds_read_b128 v[140:143], v30 offset:1600
    buffer_load_dwordx4 v19, s[24:27], s58 offen offset:3072 lds
    s_add_u32 s58, s58, 28672
    ds_read_b64_tr_b16 a[74:75], v24 offset:19456
    v_mfma_f32_16x16x32_bf16 a[244:247], v[100:103], v[176:179], a[244:247]
    ds_read_b64_tr_b16 a[78:79], v25 offset:19456
    v_mfma_f32_16x16x32_bf16 a[248:251], v[104:107], v[176:179], a[248:251]
    ds_read_b64_tr_b16 v[80:81], v29 offset:2184
    v_mfma_f32_16x16x32_bf16 a[252:255], v[108:111], v[176:179], a[252:255]
    ds_read_b64_tr_b16 v[82:83], v29 offset:2176
    s_add_u32 m0, s72, 81920
    s_waitcnt lgkmcnt(2)
    buffer_load_dwordx4 v16, s[24:27], s58 offen offset:0 lds
    v_mfma_f32_16x16x32_bf16 a[240:243], v[112:115], v[160:163], a[240:243]
    ds_read_b128 v[144:147], v30 offset:2112
    v_mfma_f32_16x16x32_bf16 a[244:247], v[112:115], v[164:167], a[244:247]
    v_mfma_f32_16x16x32_bf16 a[248:251], v[112:115], v[168:171], a[248:251]
    ds_read_b64_tr_b16 v[84:85], v29 offset:2696
    buffer_load_dwordx4 v17, s[24:27], s58 offen offset:1024 lds
    v_mfma_f32_16x16x32_bf16 a[252:255], v[112:115], v[172:175], a[252:255]
    ds_read_b64_tr_b16 v[86:87], v29 offset:2688
    v_mfma_f32_16x16x32_bf16 a[244:247], v[96:99], v[180:183], a[244:247]
    ds_read_b64_tr_b16 a[80:81], v26 offset:32768
    ds_read_b64_tr_b16 a[84:85], v27 offset:32768
    v_mfma_f32_16x16x32_bf16 a[248:251], v[100:103], v[180:183], a[248:251]
    ds_read_b128 v[148:151], v30 offset:2624
    buffer_load_dwordx4 v18, s[24:27], s58 offen offset:2048 lds
    ds_read_b64_tr_b16 a[82:83], v26 offset:33792
    v_mfma_f32_16x16x32_bf16 a[252:255], v[104:107], v[180:183], a[252:255]
    ds_read_b64_tr_b16 v[88:89], v29 offset:3208
    ds_read_b64_tr_b16 a[86:87], v27 offset:33792
    v_mfma_f32_16x16x32_bf16 a[244:247], v[116:119], v[160:163], a[244:247]
    ds_read_b64_tr_b16 v[90:91], v29 offset:3200
    ds_read_b64_tr_b16 a[88:89], v26 offset:34816
    ds_read_b64_tr_b16 a[92:93], v27 offset:34816
    v_mfma_f32_16x16x32_bf16 a[248:251], v[116:119], v[164:167], a[248:251]
    buffer_load_dwordx4 v19, s[24:27], s58 offen offset:3072 lds
    s_add_u32 s58, s58, 28672
    ds_read_b64_tr_b16 a[90:91], v26 offset:35840
    v_mfma_f32_16x16x32_bf16 a[252:255], v[116:119], v[168:171], a[252:255]
    ds_read_b128 v[152:155], v30 offset:3136
    ds_read_b64_tr_b16 a[94:95], v27 offset:35840
    v_mfma_f32_16x16x32_bf16 a[248:251], v[96:99], v[184:187], a[248:251]
    ds_read_b64_tr_b16 v[92:93], v29 offset:3720
    v_mfma_f32_16x16x32_bf16 a[252:255], v[100:103], v[184:187], a[252:255]
    s_add_u32 m0, s72, 32768
    s_waitcnt lgkmcnt(1)
    buffer_load_dwordx4 v16, s[24:27], s58 offen offset:0 lds
    v_mfma_f32_16x16x32_bf16 a[248:251], v[120:123], v[160:163], a[248:251]
    ds_read_b64_tr_b16 v[94:95], v29 offset:3712
    v_mfma_f32_16x16x32_bf16 a[252:255], v[120:123], v[164:167], a[252:255]
    ds_read_b128 v[156:159], v30 offset:3648
    v_mfma_f32_16x16x32_bf16 a[252:255], v[96:99], v[188:191], a[252:255]
    buffer_load_dwordx4 v17, s[24:27], s58 offen offset:1024 lds
    v_mfma_f32_16x16x32_bf16 a[252:255], v[124:127], v[160:163], a[252:255]
    s_waitcnt lgkmcnt(0)
    v_mfma_f32_16x16x32_bf16 a[224:227], v[64:67], v[128:131], a[224:227]
    s_waitcnt vmcnt(19)
    ds_read_b64_tr_b16 a[96:97], v26 offset:49152
    ds_read_b64_tr_b16 a[100:101], v27 offset:49152
    v_mov_b32 v14, s47
    s_mov_b64 exec, 0x7f
    buffer_load_dword v14, v13, s[32:35], s49 offen sc1
    s_mov_b64 exec, -1
    v_mfma_f32_16x16x32_bf16 a[228:231], v[64:67], v[132:135], a[228:231]
    ds_read_b64_tr_b16 v[96:97], v29 offset:200
    buffer_load_dwordx4 v18, s[24:27], s58 offen offset:2048 lds
    ds_read_b64_tr_b16 a[98:99], v26 offset:50176
    v_mfma_f32_16x16x32_bf16 a[232:235], v[68:71], v[132:135], a[232:235]
    ds_read_b64_tr_b16 v[98:99], v29 offset:192
    ds_read_b64_tr_b16 a[102:103], v27 offset:50176
    v_mfma_f32_16x16x32_bf16 a[228:231], v[68:71], v[128:131], a[228:231]
    ds_read_b128 v[160:163], v30 offset:0
    ds_read_b64_tr_b16 a[104:105], v26 offset:51200
    ds_read_b64_tr_b16 a[108:109], v27 offset:51200
    v_mfma_f32_16x16x32_bf16 a[232:235], v[64:67], v[136:139], a[232:235]
    buffer_load_dwordx4 v19, s[24:27], s58 offen offset:3072 lds
    s_add_u32 s58, s58, 28672
    ds_read_b64_tr_b16 a[106:107], v26 offset:52224
    v_mfma_f32_16x16x32_bf16 a[236:239], v[68:71], v[136:139], a[236:239]
    ds_read_b64_tr_b16 v[100:101], v29 offset:712
    ds_read_b64_tr_b16 a[110:111], v27 offset:52224
    v_mfma_f32_16x16x32_bf16 a[240:243], v[72:75], v[136:139], a[240:243]
    ds_read_b64_tr_b16 v[102:103], v29 offset:704
    v_mfma_f32_16x16x32_bf16 a[232:235], v[72:75], v[128:131], a[232:235]
    s_add_u32 m0, s72, 49152
    s_waitcnt lgkmcnt(1)
    buffer_load_dwordx4 v16, s[24:27], s58 offen offset:0 lds
    v_mfma_f32_16x16x32_bf16 a[236:239], v[72:75], v[132:135], a[236:239]
    ds_read_b128 v[164:167], v30 offset:512
    v_mfma_f32_16x16x32_bf16 a[236:239], v[64:67], v[140:143], a[236:239]
    ds_read_b64_tr_b16 v[104:105], v29 offset:1224
    v_mfma_f32_16x16x32_bf16 a[240:243], v[68:71], v[140:143], a[240:243]
    ds_read_b64_tr_b16 v[106:107], v29 offset:1216
    buffer_load_dwordx4 v17, s[24:27], s58 offen offset:1024 lds
    v_mfma_f32_16x16x32_bf16 a[244:247], v[72:75], v[140:143], a[244:247]
    v_mfma_f32_16x16x32_bf16 a[248:251], v[76:79], v[140:143], a[248:251]
    ds_read_b128 v[168:171], v30 offset:1024
    s_waitcnt vmcnt(19)
    ds_read_b64_tr_b16 a[112:113], v26 offset:0
    ds_read_b64_tr_b16 a[116:117], v27 offset:0
    v_mfma_f32_16x16x32_bf16 a[236:239], v[76:79], v[128:131], a[236:239]
    ds_read_b64_tr_b16 v[108:109], v29 offset:1736
    buffer_load_dwordx4 v18, s[24:27], s58 offen offset:2048 lds
    ds_read_b64_tr_b16 a[114:115], v26 offset:1024
    v_mfma_f32_16x16x32_bf16 a[240:243], v[76:79], v[132:135], a[240:243]
    ds_read_b64_tr_b16 a[118:119], v27 offset:1024
    v_mfma_f32_16x16x32_bf16 a[244:247], v[76:79], v[136:139], a[244:247]
    ds_read_b64_tr_b16 v[110:111], v29 offset:1728
    ds_read_b64_tr_b16 a[120:121], v26 offset:2048
    ds_read_b64_tr_b16 a[124:125], v27 offset:2048
    v_mfma_f32_16x16x32_bf16 a[240:243], v[64:67], v[144:147], a[240:243]
    ds_read_b128 v[172:175], v30 offset:1536
    buffer_load_dwordx4 v19, s[24:27], s58 offen offset:3072 lds
    s_add_u32 s58, s58, 28672
    ds_read_b64_tr_b16 a[122:123], v26 offset:3072
    v_mfma_f32_16x16x32_bf16 a[244:247], v[68:71], v[144:147], a[244:247]
    ds_read_b64_tr_b16 a[126:127], v27 offset:3072
    v_mfma_f32_16x16x32_bf16 a[248:251], v[72:75], v[144:147], a[248:251]
    ds_read_b64_tr_b16 v[112:113], v29 offset:2248
    v_mfma_f32_16x16x32_bf16 a[252:255], v[76:79], v[144:147], a[252:255]
    ds_read_b64_tr_b16 v[114:115], v29 offset:2240
    s_add_u32 m0, s72, 0
    s_waitcnt lgkmcnt(2)
    buffer_load_dwordx4 v16, s[24:27], s58 offen offset:0 lds
    v_mfma_f32_16x16x32_bf16 a[240:243], v[80:83], v[128:131], a[240:243]
    ds_read_b128 v[176:179], v30 offset:2048
    v_mfma_f32_16x16x32_bf16 a[244:247], v[80:83], v[132:135], a[244:247]
    v_mfma_f32_16x16x32_bf16 a[248:251], v[80:83], v[136:139], a[248:251]
    ds_read_b64_tr_b16 v[116:117], v29 offset:2760
    buffer_load_dwordx4 v17, s[24:27], s58 offen offset:1024 lds
    v_mfma_f32_16x16x32_bf16 a[252:255], v[80:83], v[140:143], a[252:255]
    ds_read_b64_tr_b16 v[118:119], v29 offset:2752
    v_mfma_f32_16x16x32_bf16 a[244:247], v[64:67], v[148:151], a[244:247]
    v_mfma_f32_16x16x32_bf16 a[248:251], v[68:71], v[148:151], a[248:251]
    ds_read_b128 v[180:183], v30 offset:2560
    buffer_load_dwordx4 v18, s[24:27], s58 offen offset:2048 lds
    v_mfma_f32_16x16x32_bf16 a[252:255], v[72:75], v[148:151], a[252:255]
    ds_read_b64_tr_b16 v[120:121], v29 offset:3272
    v_mfma_f32_16x16x32_bf16 a[244:247], v[84:87], v[128:131], a[244:247]
    ds_read_b64_tr_b16 v[122:123], v29 offset:3264
    v_mfma_f32_16x16x32_bf16 a[248:251], v[84:87], v[132:135], a[248:251]
    buffer_load_dwordx4 v19, s[24:27], s58 offen offset:3072 lds
    v_mfma_f32_16x16x32_bf16 a[252:255], v[84:87], v[136:139], a[252:255]
    ds_read_b128 v[184:187], v30 offset:3072
    v_mfma_f32_16x16x32_bf16 a[248:251], v[64:67], v[152:155], a[248:251]
    ds_read_b64_tr_b16 v[124:125], v29 offset:3784
    v_mfma_f32_16x16x32_bf16 a[252:255], v[68:71], v[152:155], a[252:255]
    v_mfma_f32_16x16x32_bf16 a[248:251], v[88:91], v[128:131], a[248:251]
    ds_read_b64_tr_b16 v[126:127], v29 offset:3776
    v_mfma_f32_16x16x32_bf16 a[252:255], v[88:91], v[132:135], a[252:255]
    ds_read_b128 v[188:191], v30 offset:3584
    v_mfma_f32_16x16x32_bf16 a[252:255], v[64:67], v[156:159], a[252:255]
    v_mfma_f32_16x16x32_bf16 a[252:255], v[92:95], v[128:131], a[252:255]
    s_waitcnt lgkmcnt(0)
    v_mfma_f32_16x16x32_bf16 a[224:227], v[96:99], v[160:163], a[224:227]
    s_waitcnt vmcnt(10)
    v_cmp_ne_u32 vcc, s47, v14
    s_nop 0
    s_nop 0
    s_cbranch_vccz L_ok_13
    s_mov_b32 s71, 0
L_poll_14:
    v_mov_b32 v14, s47
    s_mov_b64 exec, 0x7f
    buffer_load_dword v14, v13, s[32:35], s49 offen sc1
    s_mov_b64 exec, -1
    s_waitcnt vmcnt(0)
    v_cmp_ne_u32 vcc, s47, v14
    s_add_u32 s71, s71, 1
    s_cmp_gt_u32 s71, 0x40000
    s_cbranch_vccz L_polld_15
    s_cbranch_scc0 L_poll_14
L_polld_15:
L_ok_13:
    v_mfma_f32_16x16x32_bf16 a[228:231], v[96:99], v[164:167], a[228:231]
    buffer_load_dwordx4 v[32:35], v9, s[32:35], s59 offen offset:0 sc1
    v_mfma_f32_16x16x32_bf16 a[232:235], v[100:103], v[164:167], a[232:235]
    v_mfma_f32_16x16x32_bf16 a[228:231], v[100:103], v[160:163], a[228:231]
    buffer_load_dwordx4 v[36:39], v9, s[32:35], s59 offen offset:1024 sc1
    v_mfma_f32_16x16x32_bf16 a[232:235], v[96:99], v[168:171], a[232:235]
    v_mfma_f32_16x16x32_bf16 a[236:239], v[100:103], v[168:171], a[236:239]
    v_mfma_f32_16x16x32_bf16 a[240:243], v[104:107], v[168:171], a[240:243]
    buffer_load_dwordx4 v[40:43], v9, s[32:35], s59 offen offset:2048 sc1
    v_mfma_f32_16x16x32_bf16 a[232:235], v[104:107], v[160:163], a[232:235]
    v_mfma_f32_16x16x32_bf16 a[236:239], v[104:107], v[164:167], a[236:239]
    v_mfma_f32_16x16x32_bf16 a[236:239], v[96:99], v[172:175], a[236:239]
    buffer_load_dwordx4 v[44:47], v9, s[32:35], s59 offen offset:3072 sc1
    s_add_u32 s59, s59, 4096
    v_mfma_f32_16x16x32_bf16 a[240:243], v[100:103], v[172:175], a[240:243]
    v_mfma_f32_16x16x32_bf16 a[244:247], v[104:107], v[172:175], a[244:247]
    v_mfma_f32_16x16x32_bf16 a[248:251], v[108:111], v[172:175], a[248:251]
    buffer_load_dwordx4 v[48:51], v9, s[32:35], s59 offen offset:0 sc1
    v_mfma_f32_16x16x32_bf16 a[236:239], v[108:111], v[160:163], a[236:239]
    v_mfma_f32_16x16x32_bf16 a[240:243], v[108:111], v[164:167], a[240:243]
    v_mfma_f32_16x16x32_bf16 a[244:247], v[108:111], v[168:171], a[244:247]
    buffer_load_dwordx4 v[52:55], v9, s[32:35], s59 offen offset:1024 sc1
    v_mfma_f32_16x16x32_bf16 a[240:243], v[96:99], v[176:179], a[240:243]
    v_mfma_f32_16x16x32_bf16 a[244:247], v[100:103], v[176:179], a[244:247]
    v_mfma_f32_16x16x32_bf16 a[248:251], v[104:107], v[176:179], a[248:251]
    buffer_load_dwordx4 v[56:59], v9, s[32:35], s59 offen offset:2048 sc1
    v_mfma_f32_16x16x32_bf16 a[252:255], v[108:111], v[176:179], a[252:255]
    v_mfma_f32_16x16x32_bf16 a[240:243], v[112:115], v[160:163], a[240:243]
    v_mfma_f32_16x16x32_bf16 a[244:247], v[112:115], v[164:167], a[244:247]
    buffer_load_dwordx4 v[60:63], v9, s[32:35], s59 offen offset:3072 sc1
    s_add_u32 s59, s59, 4096
    v_mfma_f32_16x16x32_bf16 a[248:251], v[112:115], v[168:171], a[248:251]
    v_mfma_f32_16x16x32_bf16 a[252:255], v[112:115], v[172:175], a[252:255]
    v_mfma_f32_16x16x32_bf16 a[244:247], v[96:99], v[180:183], a[244:247]
    buffer_load_dwordx4 v[64:67], v9, s[32:35], s59 offen offset:0 sc1
    v_mfma_f32_16x16x32_bf16 a[248:251], v[100:103], v[180:183], a[248:251]
    v_mfma_f32_16x16x32_bf16 a[252:255], v[104:107], v[180:183], a[252:255]
    v_mfma_f32_16x16x32_bf16 a[244:247], v[116:119], v[160:163], a[244:247]
    buffer_load_dwordx4 v[68:71], v9, s[32:35], s59 offen offset:1024 sc1
    v_mfma_f32_16x16x32_bf16 a[248:251], v[116:119], v[164:167], a[248:251]
    v_mfma_f32_16x16x32_bf16 a[252:255], v[116:119], v[168:171], a[252:255]
    v_mfma_f32_16x16x32_bf16 a[248:251], v[96:99], v[184:187], a[248:251]
    buffer_load_dwordx4 v[72:75], v9, s[32:35], s59 offen offset:2048 sc1
    v_mfma_f32_16x16x32_bf16 a[252:255], v[100:103], v[184:187], a[252:255]
    v_mfma_f32_16x16x32_bf16 a[248:251], v[120:123], v[160:163], a[248:251]
    v_mfma_f32_16x16x32_bf16 a[252:255], v[120:123], v[164:167], a[252:255]
    buffer_load_dwordx4 v[76:79], v9, s[32:35], s59 offen offset:3072 sc1
    s_add_u32 s59, s59, 4096
    v_mfma_f32_16x16x32_bf16 a[252:255], v[96:99], v[188:191], a[252:255]
    v_mfma_f32_16x16x32_bf16 a[252:255], v[124:127], v[160:163], a[252:255]
    ds_read_b64 v[180:181], v22 offset:0
    ds_read_b64 v[182:183], v22 offset:512
    ds_read_b64 v[184:185], v22 offset:1024
    ds_read_b64 v[186:187], v22 offset:1536
    s_cmp_eq_u32 s75, 1
    s_cbranch_scc1 L_ch1_16
    s_waitcnt vmcnt(11)
    v_mfma_f32_32x32x16_bf16 v[224:239], a[0:3], v[32:35], 0
    buffer_load_dwordx4 v[80:83], v9, s[32:35], s59 offen offset:0 sc1
    ds_write_b128 v20, a[240:243] offset:0
    v_mfma_f32_32x32x16_bf16 v[240:255], a[4:7], v[32:35], 0
    ds_write_b128 v20, a[244:247] offset:1024
    v_accvgpr_read_b32 v192, a224
    v_accvgpr_read_b32 v193, a225
    v_accvgpr_read_b32 v194, a226
    v_accvgpr_read_b32 v195, a227
    s_waitcnt vmcnt(11)
    v_mfma_f32_32x32x16_bf16 v[224:239], a[8:11], v[36:39], v[224:239]
    buffer_load_dwordx4 v[84:87], v9, s[32:35], s59 offen offset:1024 sc1
    ds_write_b128 v20, a[248:251] offset:2048
    v_accvgpr_read_b32 v196, a228
    v_accvgpr_read_b32 v197, a229
    v_accvgpr_read_b32 v198, a230
    v_accvgpr_read_b32 v199, a231
    v_mfma_f32_32x32x16_bf16 v[240:255], a[12:15], v[36:39], v[240:255]
    ds_write_b128 v20, a[252:255] offset:3072
    v_accvgpr_read_b32 v200, a232
    v_accvgpr_read_b32 v201, a233
    v_accvgpr_read_b32 v202, a234
    v_accvgpr_read_b32 v203, a235
    s_waitcnt vmcnt(11)
    v_mfma_f32_32x32x16_bf16 v[224:239], a[16:19], v[40:43], v[224:239]
    buffer_load_dwordx4 v[88:91], v9, s[32:35], s59 offen offset:2048 sc1
    v_accvgpr_read_b32 v204, a236
    v_accvgpr_read_b32 v205, a237
    v_accvgpr_read_b32 v206, a238
    v_accvgpr_read_b32 v207, a239
    s_branch L_chj_17
L_ch1_16:
    s_waitcnt vmcnt(11)
    v_mfma_f32_32x32x16_bf16 v[224:239], a[0:3], v[32:35], 0
    buffer_load_dwordx4 v[80:83], v9, s[32:35], s59 offen offset:0 sc1
    ds_write_b128 v20, a[224:227] offset:0
    v_mfma_f32_32x32x16_bf16 v[240:255], a[4:7], v[32:35], 0
    ds_write_b128 v20, a[228:231] offset:1024
    v_accvgpr_read_b32 v192, a240
    v_accvgpr_read_b32 v193, a241
    v_accvgpr_read_b32 v194, a242
    v_accvgpr_read_b32 v195, a243
    s_waitcnt vmcnt(11)
    v_mfma_f32_32x32x16_bf16 v[224:239], a[8:11], v[36:39], v[224:239]
    buffer_load_dwordx4 v[84:87], v9, s[32:35], s59 offen offset:1024 sc1
    ds_write_b128 v20, a[232:235] offset:2048
    v_accvgpr_read_b32 v196, a244
    v_accvgpr_read_b32 v197, a245
    v_accvgpr_read_b32 v198, a246
    v_accvgpr_read_b32 v199, a247
    v_mfma_f32_32x32x16_bf16 v[240:255], a[12:15], v[36:39], v[240:255]
    ds_write_b128 v20, a[236:239] offset:3072
    v_accvgpr_read_b32 v200, a248
    v_accvgpr_read_b32 v201, a249
    v_accvgpr_read_b32 v202, a250
    v_accvgpr_read_b32 v203, a251
    s_waitcnt vmcnt(11)
    v_mfma_f32_32x32x16_bf16 v[224:239], a[16:19], v[40:43], v[224:239]
    buffer_load_dwordx4 v[88:91], v9, s[32:35], s59 offen offset:2048 sc1
    v_accvgpr_read_b32 v204, a252
    v_accvgpr_read_b32 v205, a253
    v_accvgpr_read_b32 v206, a254
    v_accvgpr_read_b32 v207, a255
L_chj_17:
    v_mfma_f32_32x32x16_bf16 v[240:255], a[20:23], v[40:43], v[240:255]
    s_waitcnt lgkmcnt(4)
    v_lshlrev_b32 v168, 16, v180
    v_and_b32 v169, s74, v180
    v_lshlrev_b32 v170, 16, v181
    v_and_b32 v171, s74, v181
    v_fmac_f32 v192, s46, v168
    s_waitcnt vmcnt(11)
    v_mfma_f32_32x32x16_bf16 v[224:239], a[24:27], v[44:47], v[224:239]
    buffer_load_dwordx4 v[92:95], v9, s[32:35], s59 offen offset:3072 sc1
    s_add_u32 s59, s59, 4096
    s_waitcnt lgkmcnt(0)
    s_barrier
    v_fmac_f32 v193, s46, v169
    v_fmac_f32 v194, s46, v170
    v_fmac_f32 v195, s46, v171
    v_lshlrev_b32 v168, 16, v182
    v_and_b32_e64 v169, s74, v182
    v_mfma_f32_32x32x16_bf16 v[240:255], a[28:31], v[44:47], v[240:255]
    ds_read_b128 v[208:211], v21 offset:0
    ds_read_b128 v[212:215], v21 offset:1024
    ds_read_b128 v[216:219], v21 offset:2048
    ds_read_b128 v[220:223], v21 offset:3072
    v_lshlrev_b32 v170, 16, v183
    v_and_b32 v171, s74, v183
    v_fmac_f32 v196, s46, v168
    v_fmac_f32 v197, s46, v169
    v_fmac_f32 v198, s46, v170
    v_fmac_f32 v199, s46, v171
    s_waitcnt vmcnt(11)
    v_mfma_f32_32x32x16_bf16 v[224:239], a[32:35], v[48:51], v[224:239]
    buffer_load_dwordx4 v[128:131], v9, s[32:35], s59 offen offset:0 sc1
    v_lshlrev_b32 v168, 16, v184
    v_and_b32 v169, s74, v184
    v_lshlrev_b32 v170, 16, v185
    v_and_b32 v171, s74, v185
    v_fmac_f32 v200, s46, v168
    v_mfma_f32_32x32x16_bf16 v[240:255], a[36:39], v[48:51], v[240:255]
    v_fmac_f32 v201, s46, v169
    v_fmac_f32 v202, s46, v170
    v_fmac_f32 v203, s46, v171
    v_lshlrev_b32 v168, 16, v186
    v_and_b32 v169, s74, v186
    v_lshlrev_b32_e64 v170, 16, v187
    s_waitcnt vmcnt(11)
    v_mfma_f32_32x32x16_bf16 v[224:239], a[40:43], v[52:55], v[224:239]
    buffer_load_dwordx4 v[132:135], v9, s[32:35], s59 offen offset:1024 sc1
    v_and_b32 v171, s74, v187
    v_fmac_f32 v204, s46, v168
    v_fmac_f32 v205, s46, v169
    v_fmac_f32 v206, s46, v170
    v_fmac_f32_e64 v207, s46, v171
    v_mfma_f32_32x32x16_bf16 v[240:255], a[44:47], v[52:55], v[240:255]
    s_waitcnt lgkmcnt(3)
    v_add_f32 v192, v192, v208
    v_add_f32 v193, v193, v209
    v_add_f32 v194, v194, v210
    v_add_f32_e64 v195, v195, v211
    v_cvt_pk_bf16_f32 v172, v192, v193
    v_cvt_pk_bf16_f32 v173, v194, v195
    s_waitcnt vmcnt(11)
    v_mfma_f32_32x32x16_bf16 v[224:239], a[48:51], v[56:59], v[224:239]
    buffer_load_dwordx4 v[136:139], v9, s[32:35], s59 offen offset:2048 sc1
    buffer_store_dwordx2 v[172:173], v23, s[32:35], s63 offen offset:0 sc1
    s_waitcnt lgkmcnt(2)
    v_add_f32 v196, v196, v212
    v_add_f32 v197, v197, v213
    v_add_f32 v198, v198, v214
    v_add_f32 v199, v199, v215
    v_mfma_f32_32x32x16_bf16 v[240:255], a[52:55], v[56:59], v[240:255]
    v_cvt_pk_bf16_f32 v174, v196, v197
    v_cvt_pk_bf16_f32 v175, v198, v199
    buffer_store_dwordx2 v[174:175], v23, s[32:35], s63 offen offset:512 sc1
    s_waitcnt lgkmcnt(1)
    v_add_f32 v200, v200, v216
    v_add_f32 v201, v201, v217
    v_add_f32_e64 v202, v202, v218
    s_waitcnt vmcnt(13)
    v_mfma_f32_32x32x16_bf16 v[224:239], a[56:59], v[60:63], v[224:239]
    buffer_load_dwordx4 v[140:143], v9, s[32:35], s59 offen offset:3072 sc1
    s_add_u32 s59, s59, 4096
    v_add_f32_e64 v203, v203, v219
    v_cvt_pk_bf16_f32 v176, v200, v201
    v_cvt_pk_bf16_f32 v177, v202, v203
    buffer_store_dwordx2 v[176:177], v23, s[32:35], s63 offen offset:1024 sc1
    s_waitcnt lgkmcnt(0)
    v_add_f32 v204, v204, v220
    v_mfma_f32_32x32x16_bf16 v[240:255], a[60:63], v[60:63], v[240:255]
    v_add_f32 v205, v205, v221
    v_add_f32 v206, v206, v222
    v_add_f32_e64 v207, v207, v223
    v_cvt_pk_bf16_f32 v178, v204, v205
    v_cvt_pk_bf16_f32 v179, v206, v207
    buffer_store_dwordx2 v[178:179], v23, s[32:35], s63 offen offset:1536 sc1
    s_waitcnt vmcnt(15)
    v_mfma_f32_32x32x16_bf16 v[224:239], a[64:67], v[64:67], v[224:239]
    buffer_load_dwordx4 v[144:147], v9, s[32:35], s59 offen offset:0 sc1
    v_mfma_f32_32x32x16_bf16 v[240:255], a[68:71], v[64:67], v[240:255]
    ds_read_b64_tr_b16 a[128:129], v24 offset:0
    ds_read_b64_tr_b16 a[132:133], v25 offset:0
    s_waitcnt vmcnt(15)
    v_mfma_f32_32x32x16_bf16 v[224:239], a[72:75], v[68:71], v[224:239]
    buffer_load_dwordx4 v[148:151], v9, s[32:35], s59 offen offset:1024 sc1
    ds_read_b64_tr_b16 a[130:131], v24 offset:1024
    v_mfma_f32_32x32x16_bf16 v[240:255], a[76:79], v[68:71], v[240:255]
    ds_read_b64_tr_b16 a[134:135], v25 offset:1024
    ds_read_b64_tr_b16 a[136:137], v24 offset:2048
    s_waitcnt vmcnt(15)
    v_mfma_f32_32x32x16_bf16 v[224:239], a[80:83], v[72:75], v[224:239]
    buffer_load_dwordx4 v[152:155], v9, s[32:35], s59 offen offset:2048 sc1
    ds_read_b64_tr_b16 a[140:141], v25 offset:2048
    v_mfma_f32_32x32x16_bf16 v[240:255], a[84:87], v[72:75], v[240:255]
    ds_read_b64_tr_b16 a[138:139], v24 offset:3072
    ds_read_b64_tr_b16 a[142:143], v25 offset:3072
    s_waitcnt vmcnt(15)
    v_mfma_f32_32x32x16_bf16 v[224:239], a[88:91], v[76:79], v[224:239]
    buffer_load_dwordx4 v[156:159], v9, s[32:35], s59 offen offset:3072 sc1
    s_add_u32 s59, s59, 4096
    ds_read_b64_tr_b16 a[144:145], v26 offset:16384
    v_mfma_f32_32x32x16_bf16 v[240:255], a[92:95], v[76:79], v[240:255]
    ds_read_b64_tr_b16 a[148:149], v27 offset:16384
    ds_read_b64_tr_b16 a[146:147], v26 offset:17408
    s_waitcnt vmcnt(15)
    v_mfma_f32_32x32x16_bf16 v[224:239], a[96:99], v[80:83], v[224:239]
    buffer_load_dwordx4 v[96:99], v9, s[32:35], s59 offen offset:0 sc1
    ds_read_b64_tr_b16 a[150:151], v27 offset:17408
    v_mfma_f32_32x32x16_bf16 v[240:255], a[100:103], v[80:83], v[240:255]
    ds_read_b64_tr_b16 a[152:153], v26 offset:18432
    ds_read_b64_tr_b16 a[156:157], v27 offset:18432
    s_waitcnt vmcnt(15)
    v_mfma_f32_32x32x16_bf16 v[224:239], a[104:107], v[84:87], v[224:239]
    buffer_load_dwordx4 v[100:103], v9, s[32:35], s59 offen offset:1024 sc1
    ds_read_b64_tr_b16 a[154:155], v26 offset:19456
    ds_read_b64_tr_b16 a[160:161], v24 offset:16384
    ds_read_b64_tr_b16 a[164:165], v25 offset:16384
    ds_read_b64_tr_b16 a[162:163], v24 offset:17408
    s_waitcnt lgkmcnt(10)
    s_add_u32 m0, s72, 65536
    s_nop 0
    buffer_load_dwordx4 v10, s[8:11], s64 offen lds
    v_mfma_f32_32x32x16_bf16 v[240:255], a[108:111], v[84:87], v[240:255]
    ds_read_b64_tr_b16 a[158:159], v27 offset:19456
    ds_read_b64_tr_b16 a[166:167], v25 offset:17408
    ds_read_b64_tr_b16 a[168:169], v24 offset:18432
    ds_read_b64_tr_b16 a[172:173], v25 offset:18432
    s_waitcnt vmcnt(16)
    v_mfma_f32_32x32x16_bf16 v[224:239], a[112:115], v[88:91], v[224:239]
    buffer_load_dwordx4 v[104:107], v9, s[32:35], s59 offen offset:2048 sc1
    ds_read_b64_tr_b16 a[170:171], v24 offset:19456
    ds_read_b64_tr_b16 a[174:175], v25 offset:19456
    v_mfma_f32_32x32x16_bf16 v[240:255], a[116:119], v[88:91], v[240:255]
    ds_read_b64_tr_b16 a[176:177], v26 offset:32768
    ds_read_b64_tr_b16 a[180:181], v27 offset:32768
    ds_read_b64_tr_b16 a[178:179], v26 offset:33792
    buffer_load_dwordx4 v10, s[8:11], s66 offen offset:1024 lds
    s_waitcnt vmcnt(17)
    v_mfma_f32_32x32x16_bf16 v[224:239], a[120:123], v[92:95], v[224:239]
    buffer_load_dwordx4 v[108:111], v9, s[32:35], s59 offen offset:3072 sc1
    s_mov_b32 s59, s65
    s_waitcnt vmcnt(10)
    s_waitcnt lgkmcnt(8)
    ds_read_b64_tr_b16 a[182:183], v27 offset:33792
    ds_read_b64_tr_b16 a[184:185], v26 offset:34816
    ds_read_b64_tr_b16 a[188:189], v27 offset:34816
    v_mfma_f32_32x32x16_bf16 v[240:255], a[124:127], v[92:95], v[240:255]
    v_mov_b32 v2, s47
    v_mov_b32_e64 v3, s47
    ds_read_b64_tr_b16 a[186:187], v26 offset:35840
    ds_read_b64_tr_b16 a[190:191], v27 offset:35840
    v_mfma_f32_32x32x16_bf16 v[224:239], a[128:131], v[128:131], v[224:239]
    buffer_load_dwordx4 v[112:115], v8, s[32:35], s59 offen offset:0 sc1
    s_mov_b64 exec, 0xffff
    buffer_store_dwordx2 v[2:3], v12, s[32:35], s81 offen sc1
    s_mov_b64 exec, -1
    ds_read_b64_tr_b16 a[192:193], v26 offset:49152
    ds_read_b64_tr_b16 a[196:197], v27 offset:49152
    ds_read_b64_tr_b16 a[194:195], v26 offset:50176
    v_mfma_f32_32x32x16_bf16 v[240:255], a[132:135], v[128:131], v[240:255]
    ds_read_b64_tr_b16 a[198:199], v27 offset:50176
    ds_read_b64_tr_b16 a[200:201], v26 offset:51200
    ds_read_b64_tr_b16 a[204:205], v27 offset:51200
    v_mfma_f32_32x32x16_bf16 v[224:239], a[136:139], v[132:135], v[224:239]
    buffer_load_dwordx4 v[116:119], v8, s[32:35], s59 offen offset:1024 sc1
    buffer_load_dwordx2 v[14:15], v12, s[32:35], s50 offen sc1
    ds_read_b64_tr_b16 a[202:203], v26 offset:52224
    ds_read_b64_tr_b16 a[206:207], v27 offset:52224
    v_mfma_f32_32x32x16_bf16 v[240:255], a[140:143], v[132:135], v[240:255]
    ds_read_b64_tr_b16 a[208:209], v26 offset:0
    ds_read_b64_tr_b16 a[212:213], v27 offset:0
    ds_read_b64_tr_b16 a[210:211], v26 offset:1024
    v_mfma_f32_32x32x16_bf16 v[224:239], a[144:147], v[136:139], v[224:239]
    buffer_load_dwordx4 v[120:123], v8, s[32:35], s59 offen offset:2048 sc1
    ds_read_b64_tr_b16 a[214:215], v27 offset:1024
    ds_read_b64_tr_b16 a[216:217], v26 offset:2048
    ds_read_b64_tr_b16 a[220:221], v27 offset:2048
    v_mfma_f32_32x32x16_bf16 v[240:255], a[148:151], v[136:139], v[240:255]
    ds_read_b64_tr_b16 a[218:219], v26 offset:3072
    ds_read_b64_tr_b16 a[222:223], v27 offset:3072
    v_mfma_f32_32x32x16_bf16 v[224:239], a[152:155], v[140:143], v[224:239]
    buffer_load_dwordx4 v[124:127], v8, s[32:35], s59 offen offset:3072 sc1
    s_add_u32 s59, s59, 4096
    v_mfma_f32_32x32x16_bf16 v[240:255], a[156:159], v[140:143], v[240:255]
    s_waitcnt lgkmcnt(0)
    s_waitcnt vmcnt(15)
    v_mfma_f32_32x32x16_bf16 v[224:239], a[160:163], v[144:147], v[224:239]
    buffer_load_dwordx4 v[160:163], v8, s[32:35], s59 offen offset:0 sc1
    s_xor_b32 s4, s3, 1
    s_lshl_b32 s4, s4, 12
    s_add_u32 s4, s4, 98304
    v_add_u32 v17, s4, v28
    v_mfma_f32_32x32x16_bf16 v[240:255], a[164:167], v[144:147], v[240:255]
    s_xor_b32 s4, s3, 2
    s_lshl_b32 s4, s4, 12
    s_add_u32 s4, s4, 114688
    v_add_u32 v18, s4, v28
    s_waitcnt vmcnt(15)
    v_mfma_f32_32x32x16_bf16 v[224:239], a[168:171], v[148:151], v[224:239]
    buffer_load_dwordx4 v[164:167], v8, s[32:35], s59 offen offset:1024 sc1
    s_xor_b32 s4, s3, 3
    s_lshl_b32 s4, s4, 12
    s_add_u32 s4, s4, 135936
    v_add_u32_e64 v19, s4, v28
    v_mfma_f32_32x32x16_bf16 v[240:255], a[172:175], v[148:151], v[240:255]
    v_add_u32 v16, s72, v28
    s_waitcnt vmcnt(15)
    v_mfma_f32_32x32x16_bf16 v[224:239], a[176:179], v[152:155], v[224:239]
    buffer_load_dwordx4 v[168:171], v8, s[32:35], s59 offen offset:2048 sc1
    v_add_u32 v20, 98304, v16
    v_add_u32 v21, 114688, v16
    v_mfma_f32_32x32x16_bf16 v[240:255], a[180:183], v[152:155], v[240:255]
    v_add_u32 v22, 135936, v16
    v_mul_u32_u24 v26, 896, v31
    s_waitcnt vmcnt(15)
    v_mfma_f32_32x32x16_bf16 v[224:239], a[184:187], v[156:159], v[224:239]
    buffer_load_dwordx4 v[172:175], v8, s[32:35], s59 offen offset:3072 sc1
    s_add_u32 s59, s59, 4096
    v_lshl_add_u32 v26, v0, 5, v26
    v_lshlrev_b32 v24, 6, v31
    v_mfma_f32_32x32x16_bf16 v[240:255], a[188:191], v[156:159], v[240:255]
    v_lshl_add_u32 v24, v0, 5, v24
    s_waitcnt vmcnt(15)
    v_mfma_f32_32x32x16_bf16 v[224:239], a[192:195], v[96:99], v[224:239]
    buffer_load_dwordx4 v[176:179], v8, s[32:35], s59 offen offset:0 sc1
    s_add_u32 s4, s72, 65536
    v_add_u32 v24, s4, v24
    v_lshl_add_u32 v25, v0, 4, v6
    v_mfma_f32_32x32x16_bf16 v[240:255], a[196:199], v[96:99], v[240:255]
    v_lshlrev_b32 v25, 6, v25
    v_and_b32_e64 v23, 1, v4
    s_waitcnt vmcnt(15)
    v_mfma_f32_32x32x16_bf16 v[224:239], a[200:203], v[100:103], v[224:239]
    buffer_load_dwordx4 v[180:183], v8, s[32:35], s59 offen offset:1024 sc1
    v_lshl_add_u32 v25, v23, 5, v25
    v_lshl_add_u32 v25, v7, 3, v25
    v_mfma_f32_32x32x16_bf16 v[240:255], a[204:207], v[100:103], v[240:255]
    s_add_u32 s4, s72, 16384
    v_add_u32 v25, s4, v25
    s_waitcnt vmcnt(14)
    v_mfma_f32_32x32x16_bf16 v[224:239], a[208:211], v[104:107], v[224:239]
    buffer_load_dwordx4 v[184:187], v8, s[32:35], s59 offen offset:2048 sc1
    v_mfma_f32_32x32x16_bf16 v[240:255], a[212:215], v[104:107], v[240:255]
    s_waitcnt vmcnt(13)
    v_mfma_f32_32x32x16_bf16 v[224:239], a[216:219], v[108:111], v[224:239]
    buffer_load_dwordx4 v[188:191], v8, s[32:35], s59 offen offset:3072 sc1
    s_add_u32 s59, s59, 4096
    s_waitcnt vmcnt(10)
    v_cmp_ne_u32 vcc, s47, v15
    s_nop 0
    s_nop 0
    s_cbranch_vccz L_ok_18
    s_mov_b32 s71, 0
L_poll_19:
    buffer_load_dwordx2 v[14:15], v12, s[32:35], s50 offen sc1
    s_waitcnt vmcnt(0)
    v_cmp_ne_u32 vcc, s47, v15
    s_add_u32 s71, s71, 1
    s_cmp_gt_u32 s71, 0x40000
    s_cbranch_vccz L_polld_20
    s_cbranch_scc0 L_poll_19
L_polld_20:
L_ok_18:
    v_lshlrev_b32 v29, 16, v14
    v_mfma_f32_32x32x16_bf16 v[240:255], a[220:223], v[108:111], v[240:255]
    v_rcp_f32 v29, v29
    v_and_b32 v30, s74, v14
    v_mul_f32 v30, v30, v29
    v_mfma_f32_32x32x16_bf16 v[192:207], a[0:3], v[112:115], 0
    buffer_load_dwordx4 v[32:35], v8, s[32:35], s59 offen offset:0 sc1
    ds_read_b128 v[96:99], v24
    v_mov_b32_e64 v27, s47
    s_mov_b32 exec_hi, 0
    buffer_load_dword v27, v13, s[32:35], s54 offen sc1
    s_mov_b64 exec, -1
    v_mfma_f32_32x32x16_bf16 v[208:223], a[4:7], v[112:115], 0
    ds_read_b128 v[100:103], v24 offset:16
    v_mfma_f32_32x32x16_bf16 v[192:207], a[8:11], v[116:119], v[192:207]
    buffer_load_dwordx4 v[36:39], v8, s[32:35], s59 offen offset:1024 sc1
    v_mfma_f32_32x32x16_bf16 v[208:223], a[12:15], v[116:119], v[208:223]
    ds_write_b128 v18, v[224:227] offset:0
    s_waitcnt vmcnt(12)
    v_mfma_f32_32x32x16_bf16 v[192:207], a[16:19], v[120:123], v[192:207]
    buffer_load_dwordx4 v[40:43], v8, s[32:35], s59 offen offset:2048 sc1
    s_waitcnt lgkmcnt(1)
    v_lshlrev_b32 v128, 16, v96
    v_and_b32 v129, s74, v96
    v_mfma_f32_32x32x16_bf16 v[208:223], a[20:23], v[120:123], v[208:223]
    ds_write_b128 v18, v[228:231] offset:1024
    v_lshlrev_b32 v130, 16, v97
    v_and_b32 v131, s74, v97
    v_lshlrev_b32 v132, 16, v98
    s_waitcnt vmcnt(12)
    v_mfma_f32_32x32x16_bf16 v[192:207], a[24:27], v[124:127], v[192:207]
    buffer_load_dwordx4 v[44:47], v8, s[32:35], s59 offen offset:3072 sc1
    s_add_u32 s59, s59, 4096
    v_and_b32 v133, s74, v98
    v_lshlrev_b32 v134, 16, v99
    v_and_b32 v135, s74, v99
    v_mfma_f32_32x32x16_bf16 v[208:223], a[28:31], v[124:127], v[208:223]
    ds_write_b128 v18, v[232:235] offset:2048
    v_lshlrev_b32 v136, 16, v100
    v_and_b32 v137, s74, v100
    s_waitcnt vmcnt(12)
    v_mfma_f32_32x32x16_bf16 v[192:207], a[32:35], v[160:163], v[192:207]
    buffer_load_dwordx4 v[48:51], v8, s[32:35], s59 offen offset:0 sc1
    v_lshlrev_b32 v138, 16, v101
    v_and_b32 v139, s74, v101
    v_lshlrev_b32_e64 v140, 16, v102
    v_mfma_f32_32x32x16_bf16 v[208:223], a[36:39], v[160:163], v[208:223]
    ds_write_b128 v18, v[236:239] offset:3072
    v_and_b32 v141, s74, v102
    v_lshlrev_b32 v142, 16, v103
    v_and_b32 v143, s74, v103
    s_waitcnt vmcnt(12)
    v_mfma_f32_32x32x16_bf16 v[192:207], a[40:43], v[164:167], v[192:207]
    buffer_load_dwordx4 v[52:55], v8, s[32:35], s59 offen offset:1024 sc1
    v_fma_f32 v144, v128, v29, -v30
    v_fma_f32 v145, v129, v29, -v30
    v_fma_f32 v146, v130, v29, -v30
    v_mfma_f32_32x32x16_bf16 v[208:223], a[44:47], v[164:167], v[208:223]
    ds_write_b128 v19, v[240:243] offset:0
    v_fma_f32 v147, v131, v29, -v30
    v_fma_f32 v148, v132, v29, -v30
    s_waitcnt vmcnt(12)
    v_mfma_f32_32x32x16_bf16 v[192:207], a[48:51], v[168:171], v[192:207]
    buffer_load_dwordx4 v[56:59], v8, s[32:35], s59 offen offset:2048 sc1
    v_fma_f32 v149, v133, v29, -v30
    v_fma_f32 v150, v134, v29, -v30
    v_fma_f32 v151, v135, v29, -v30
    v_mfma_f32_32x32x16_bf16 v[208:223], a[52:55], v[168:171], v[208:223]
    ds_write_b128 v19, v[244:247] offset:1024
    v_fma_f32 v152, v136, v29, -v30
    v_fma_f32 v153, v137, v29, -v30
    v_fma_f32 v154, v138, v29, -v30
    s_waitcnt vmcnt(12)
    v_mfma_f32_32x32x16_bf16 v[192:207], a[56:59], v[172:175], v[192:207]
    buffer_load_dwordx4 v[60:63], v8, s[32:35], s59 offen offset:3072 sc1
    s_add_u32 s59, s59, 4096
    v_fma_f32 v155, v139, v29, -v30
    v_fma_f32 v156, v140, v29, -v30
    v_fma_f32 v157, v141, v29, -v30
    v_mfma_f32_32x32x16_bf16 v[208:223], a[60:63], v[172:175], v[208:223]
    ds_write_b128 v19, v[248:251] offset:2048
    v_fma_f32 v158, v142, v29, -v30
    v_fma_f32 v159, v143, v29, -v30
    s_waitcnt vmcnt(12)
    v_mfma_f32_32x32x16_bf16 v[192:207], a[64:67], v[176:179], v[192:207]
    buffer_load_dwordx4 v[64:67], v8, s[32:35], s59 offen offset:0 sc1
    v_mfma_f32_32x32x16_bf16 v[208:223], a[68:71], v[176:179], v[208:223]
    ds_write_b128 v19, v[252:255] offset:3072
    s_waitcnt vmcnt(12)
    v_mfma_f32_32x32x16_bf16 v[192:207], a[72:75], v[180:183], v[192:207]
    buffer_load_dwordx4 v[68:71], v8, s[32:35], s59 offen offset:1024 sc1
    v_mfma_f32_32x32x16_bf16 v[208:223], a[76:79], v[180:183], v[208:223]
    s_waitcnt vmcnt(12)
    v_mfma_f32_32x32x16_bf16 v[192:207], a[80:83], v[184:187], v[192:207]
    buffer_load_dwordx4 v[72:75], v8, s[32:35], s59 offen offset:2048 sc1
    v_mfma_f32_32x32x16_bf16 v[208:223], a[84:87], v[184:187], v[208:223]
    s_waitcnt vmcnt(12)
    v_mfma_f32_32x32x16_bf16 v[192:207], a[88:91], v[188:191], v[192:207]
    buffer_load_dwordx4 v[76:79], v8, s[32:35], s59 offen offset:3072 sc1
    s_add_u32 s59, s59, 4096
    s_waitcnt lgkmcnt(0)
    s_barrier
    v_mfma_f32_32x32x16_bf16 v[208:223], a[92:95], v[188:191], v[208:223]
    ds_read_b128 v[224:227], v21 offset:0
    ds_read_b128 v[228:231], v21 offset:1024
    s_waitcnt vmcnt(12)
    v_mfma_f32_32x32x16_bf16 v[192:207], a[96:99], v[32:35], v[192:207]
    buffer_load_dwordx4 v[80:83], v8, s[32:35], s59 offen offset:0 sc1
    ds_read_b128 v[232:235], v21 offset:2048
    ds_read_b128 v[236:239], v21 offset:3072
    s_waitcnt vmcnt(12)
    v_cmp_ne_u32 vcc, s47, v27
    s_nop 0
    s_nop 0
    s_cbranch_vccz L_ok_21
    s_mov_b32 s71, 0
L_poll_22:
    v_mov_b32 v27, s47
    s_mov_b32 exec_hi, 0
    buffer_load_dword v27, v13, s[32:35], s54 offen sc1
    s_mov_b64 exec, -1
    s_waitcnt vmcnt(0)
    v_cmp_ne_u32 vcc, s47, v27
    s_add_u32 s71, s71, 1
    s_cmp_gt_u32 s71, 0x40000
    s_cbranch_vccz L_polld_23
    s_cbranch_scc0 L_poll_22
L_polld_23:
L_ok_21:
    s_add_u32 m0, s72, 16384
    s_nop 0
    buffer_load_dwordx4 v11, s[32:35], s0 offen sc1 lds
    v_mfma_f32_32x32x16_bf16 v[208:223], a[100:103], v[32:35], v[208:223]
    ds_read_b128 v[240:243], v22 offset:0
    ds_read_b128 v[244:247], v22 offset:1024
    buffer_load_dwordx4 v11, s[32:35], s1 offen offset:1024 sc1 lds
    s_waitcnt vmcnt(13)
    v_mfma_f32_32x32x16_bf16 v[192:207], a[104:107], v[36:39], v[192:207]
    buffer_load_dwordx4 v[84:87], v8, s[32:35], s59 offen offset:1024 sc1
    ds_read_b128 v[248:251], v22 offset:2048
    ds_read_b128 v[252:255], v22 offset:3072
    v_mfma_f32_32x32x16_bf16 v[208:223], a[108:111], v[36:39], v[208:223]
    s_waitcnt vmcnt(13)
    v_mfma_f32_32x32x16_bf16 v[192:207], a[112:115], v[40:43], v[192:207]
    buffer_load_dwordx4 v[88:91], v8, s[32:35], s59 offen offset:2048 sc1
    v_mfma_f32_32x32x16_bf16 v[208:223], a[116:119], v[40:43], v[208:223]
    s_waitcnt lgkmcnt(4)
    v_add_f32 v128, v128, v224
    v_add_f32 v129, v129, v225
    v_add_f32 v130, v130, v226
    s_waitcnt vmcnt(13)
    v_mfma_f32_32x32x16_bf16 v[192:207], a[120:123], v[44:47], v[192:207]
    buffer_load_dwordx4 v[92:95], v8, s[32:35], s59 offen offset:3072 sc1
    v_add_f32 v131, v131, v227
    v_add_f32 v132, v132, v228
    v_add_f32 v133, v133, v229
    v_add_f32 v134, v134, v230
    v_mfma_f32_32x32x16_bf16 v[208:223], a[124:127], v[44:47], v[208:223]
    v_add_f32 v135, v135, v231
    v_add_f32 v136, v136, v232
    v_add_f32 v137, v137, v233
    v_add_f32 v138, v138, v234
    s_waitcnt vmcnt(13)
    v_mfma_f32_32x32x16_bf16 v[192:207], a[128:131], v[48:51], v[192:207]
    v_add_f32 v139, v139, v235
    v_add_f32 v140, v140, v236
    v_add_f32 v141, v141, v237
    v_add_f32 v142, v142, v238
    v_mfma_f32_32x32x16_bf16 v[208:223], a[132:135], v[48:51], v[208:223]
    v_add_f32 v143, v143, v239
    s_waitcnt lgkmcnt(0)
    v_add_f32 v128, v128, v240
    s_waitcnt vmcnt(12)
    v_mfma_f32_32x32x16_bf16 v[192:207], a[136:139], v[52:55], v[192:207]
    v_add_f32 v129, v129, v241
    v_add_f32 v130, v130, v242
    v_add_f32 v131, v131, v243
    v_add_f32 v132, v132, v244
    v_mfma_f32_32x32x16_bf16 v[208:223], a[140:143], v[52:55], v[208:223]
    v_add_f32 v133, v133, v245
    v_add_f32 v134, v134, v246
    v_add_f32 v135, v135, v247
    v_add_f32 v136, v136, v248
    s_waitcnt vmcnt(11)
    v_mfma_f32_32x32x16_bf16 v[192:207], a[144:147], v[56:59], v[192:207]
    v_add_f32 v137, v137, v249
    v_add_f32 v138, v138, v250
    v_add_f32 v139, v139, v251
    v_add_f32_e64 v140, v140, v252
    v_mfma_f32_32x32x16_bf16 v[208:223], a[148:151], v[56:59], v[208:223]
    v_add_f32 v141, v141, v253
    v_add_f32 v142, v142, v254
    v_add_f32 v143, v143, v255
    s_waitcnt vmcnt(10)
    v_mfma_f32_32x32x16_bf16 v[192:207], a[152:155], v[60:63], v[192:207]
    v_mfma_f32_32x32x16_bf16 v[208:223], a[156:159], v[60:63], v[208:223]
    s_waitcnt vmcnt(9)
    v_mfma_f32_32x32x16_bf16 v[192:207], a[160:163], v[64:67], v[192:207]
    v_mfma_f32_32x32x16_bf16 v[208:223], a[164:167], v[64:67], v[208:223]
    s_waitcnt vmcnt(8)
    v_mfma_f32_32x32x16_bf16 v[192:207], a[168:171], v[68:71], v[192:207]
    v_mfma_f32_32x32x16_bf16 v[208:223], a[172:175], v[68:71], v[208:223]
    s_waitcnt vmcnt(7)
    v_mfma_f32_32x32x16_bf16 v[192:207], a[176:179], v[72:75], v[192:207]
    v_mfma_f32_32x32x16_bf16 v[208:223], a[180:183], v[72:75], v[208:223]
    s_waitcnt vmcnt(6)
    v_mfma_f32_32x32x16_bf16 v[192:207], a[184:187], v[76:79], v[192:207]
    v_mfma_f32_32x32x16_bf16 v[208:223], a[188:191], v[76:79], v[208:223]
    s_waitcnt vmcnt(3)
    ds_read_b64_tr_b16 v[104:105], v25 offset:0
    ds_read_b64_tr_b16 v[106:107], v25 offset:256
    v_mfma_f32_32x32x16_bf16 v[192:207], a[192:195], v[80:83], v[192:207]
    ds_read_b64_tr_b16 v[108:109], v25 offset:512
    ds_read_b64_tr_b16 v[110:111], v25 offset:768
    v_mfma_f32_32x32x16_bf16 v[208:223], a[196:199], v[80:83], v[208:223]
    s_waitcnt vmcnt(2)
    v_mfma_f32_32x32x16_bf16 v[192:207], a[200:203], v[84:87], v[192:207]
    s_waitcnt lgkmcnt(0)
    v_lshlrev_b32 v224, 16, v104
    v_and_b32 v225, s74, v104
    v_lshlrev_b32 v226, 16, v105
    v_and_b32 v227, s74, v105
    v_lshlrev_b32 v228, 16, v106
    v_mfma_f32_32x32x16_bf16 v[208:223], a[204:207], v[84:87], v[208:223]
    v_and_b32 v229, s74, v106
    v_lshlrev_b32 v230, 16, v107
    v_and_b32 v231, s74, v107
    v_lshlrev_b32 v232, 16, v108
    v_and_b32 v233, s74, v108
    s_waitcnt vmcnt(1)
    v_mfma_f32_32x32x16_bf16 v[208:223], a[212:215], v[88:91], v[208:223]
    v_lshlrev_b32 v234, 16, v109
    v_and_b32 v235, s74, v109
    v_lshlrev_b32 v236, 16, v110
    v_and_b32 v237, s74, v110
    v_lshlrev_b32 v238, 16, v111
    v_and_b32 v239, s74, v111
    s_waitcnt vmcnt(0)
    v_mfma_f32_32x32x16_bf16 v[208:223], a[220:223], v[92:95], v[208:223]
    v_fmac_f32 v128, v144, v224
    v_fmac_f32 v129, v145, v225
    v_fmac_f32 v130, v146, v226
    v_fmac_f32 v131, v147, v227
    v_fmac_f32 v132, v148, v228
    v_mfma_f32_32x32x16_bf16 v[192:207], a[208:211], v[88:91], v[192:207]
    v_fmac_f32 v133, v149, v229
    v_fmac_f32 v134, v150, v230
    v_fmac_f32 v135, v151, v231
    v_fmac_f32 v136, v152, v232
    v_fmac_f32 v137, v153, v233
    v_fmac_f32 v138, v154, v234
    v_mfma_f32_32x32x16_bf16 v[192:207], a[216:219], v[92:95], v[192:207]
    v_fmac_f32 v139, v155, v235
    v_fmac_f32 v140, v156, v236
    v_fmac_f32 v141, v157, v237
    v_fmac_f32 v142, v158, v238
    v_fmac_f32_e64 v143, v159, v239
    s_nop 7
    s_nop 1
    ds_write_b128 v17, v[208:211] offset:0
    ds_write_b128 v17, v[212:215] offset:1024
    ds_write_b128 v17, v[216:219] offset:2048
    ds_write_b128 v17, v[220:223] offset:3072
    v_pk_add_f32 v[128:129], v[128:129], v[192:193]
    v_pk_add_f32 v[130:131], v[130:131], v[194:195]
    v_pk_add_f32 v[132:133], v[132:133], v[196:197]
    v_pk_add_f32 v[134:135], v[134:135], v[198:199]
    v_pk_add_f32 v[136:137], v[136:137], v[200:201]
    v_pk_add_f32 v[138:139], v[138:139], v[202:203]
    v_pk_add_f32 v[140:141], v[140:141], v[204:205]
    v_pk_add_f32 v[142:143], v[142:143], v[206:207]
    s_waitcnt lgkmcnt(0)
    s_barrier
    ds_read_b128 v[224:227], v20 offset:0
    ds_read_b128 v[228:231], v20 offset:1024
    ds_read_b128 v[232:235], v20 offset:2048
    ds_read_b128 v[236:239], v20 offset:3072
    s_waitcnt lgkmcnt(3)
    v_pk_add_f32 v[128:129], v[128:129], v[224:225]
    v_pk_add_f32 v[130:131], v[130:131], v[226:227]
    v_cvt_pk_bf16_f32 v96, v128, v129
    v_cvt_pk_bf16_f32 v97, v130, v131
    s_waitcnt lgkmcnt(2)
    v_pk_add_f32 v[132:133], v[132:133], v[228:229]
    v_pk_add_f32 v[134:135], v[134:135], v[230:231]
    v_cvt_pk_bf16_f32 v98, v132, v133
    v_cvt_pk_bf16_f32 v99, v134, v135
    buffer_store_dwordx4 v[96:99], v26, s[36:39], s64 offen offset:0
    s_waitcnt lgkmcnt(1)
    v_pk_add_f32 v[136:137], v[136:137], v[232:233]
    v_pk_add_f32 v[138:139], v[138:139], v[234:235]
    v_cvt_pk_bf16_f32 v100, v136, v137
    v_cvt_pk_bf16_f32 v101, v138, v139
    s_waitcnt lgkmcnt(0)
    v_pk_add_f32 v[140:141], v[140:141], v[236:237]
    v_pk_add_f32 v[142:143], v[142:143], v[238:239]
    v_cvt_pk_bf16_f32 v102, v140, v141
    v_cvt_pk_bf16_f32 v103, v142, v143
    buffer_store_dwordx4 v[100:103], v26, s[36:39], s64 offen offset:16
    s_endpgm
L_helper:
    s_load_dwordx2 s[12:13], s[0:1], 8
    s_load_dwordx2 s[16:17], s[0:1], 16
    s_load_dwordx2 s[32:33], s[0:1], 88
    s_load_dwordx2 s[40:41], s[0:1], 24
    s_load_dwordx2 s[28:29], s[0:1], 32
    s_load_dwordx2 s[44:45], s[0:1], 40
    s_load_dwordx2 s[24:25], s[0:1], 64
    s_load_dwordx2 s[36:37], s[0:1], 72
    s_mov_b32 s34, 11468800
    s_mov_b32 s35, 0x20000
    v_lshrrev_b32 v2, 6, v0
    v_and_b32 v1, 63, v0
    s_and_b32 s48, s2, 7
    v_readfirstlane_b32 s3, v2
    s_lshr_b32 s49, s2, 3
    s_mov_b32 s10, 1835008
    s_mov_b32 s11, 0x20000
    s_sub_u32 s4, s49, 28
    s_lshl_b32 s5, s48, 2
    s_add_u32 s4, s4, s5
    s_lshl_b32 s4, s4, 2
    s_add_u32 s4, s4, s3
    s_mul_i32 s5, s4, 14336
    s_add_u32 s6, s5, 7168
    v_lshrrev_b32 v4, 3, v1
    v_and_b32 v5, 7, v1
    v_mul_u32_u24 v6, 896, v4
    v_lshl_add_u32 v6, v5, 4, v6
    v_mov_b32_e64 v24, 0
    s_waitcnt lgkmcnt(0)
    buffer_load_dword v24, v24, s[32:35], 0 offen sc1
    buffer_load_dwordx4 v[32:35], v6, s[8:11], s5 offen offset:0
    buffer_load_dwordx4 v[36:39], v6, s[8:11], s5 offen offset:128
    buffer_load_dwordx4 v[40:43], v6, s[8:11], s5 offen offset:256
    buffer_load_dwordx4 v[44:47], v6, s[8:11], s5 offen offset:384
    buffer_load_dwordx4 v[48:51], v6, s[8:11], s5 offen offset:512
    buffer_load_dwordx4 v[52:55], v6, s[8:11], s5 offen offset:640
    buffer_load_dwordx4 v[56:59], v6, s[8:11], s5 offen offset:768
    buffer_load_dwordx4 v[60:63], v6, s[8:11], s6 offen offset:0
    buffer_load_dwordx4 v[64:67], v6, s[8:11], s6 offen offset:128
    buffer_load_dwordx4 v[68:71], v6, s[8:11], s6 offen offset:256
    buffer_load_dwordx4 v[72:75], v6, s[8:11], s6 offen offset:384
    buffer_load_dwordx4 v[76:79], v6, s[8:11], s6 offen offset:512
    buffer_load_dwordx4 v[80:83], v6, s[8:11], s6 offen offset:640
    buffer_load_dwordx4 v[84:87], v6, s[8:11], s6 offen offset:768
    v_mov_b32 v7, 0x3f803f80
    v_mov_b32 v8, 0
    v_mov_b32 v9, 0
    v_mov_b32 v10, 0
    v_mov_b32 v11, 0
    v_mov_b32 v12, 0
    v_mov_b32 v13, 0
    v_mov_b32_e64 v14, 0
    v_mov_b32 v15, 0
    s_waitcnt vmcnt(13)
    v_dot2_f32_bf16 v8, v32, v7, v8
    v_dot2_f32_bf16 v10, v32, v32, v10
    v_dot2_f32_bf16 v9, v33, v7, v9
    v_dot2_f32_bf16 v11, v33, v33, v11
    v_dot2_f32_bf16 v8, v34, v7, v8
    v_dot2_f32_bf16 v10, v34, v34, v10
    v_dot2_f32_bf16 v9, v35, v7, v9
    v_dot2_f32_bf16 v11, v35, v35, v11
    s_waitcnt vmcnt(12)
    v_dot2_f32_bf16 v8, v36, v7, v8
    v_dot2_f32_bf16 v10, v36, v36, v10
    v_dot2_f32_bf16 v9, v37, v7, v9
    v_dot2_f32_bf16 v11, v37, v37, v11
    v_dot2_f32_bf16 v8, v38, v7, v8
    v_dot2_f32_bf16 v10, v38, v38, v10
    v_dot2_f32_bf16 v9, v39, v7, v9
    v_dot2_f32_bf16 v11, v39, v39, v11
    s_waitcnt vmcnt(11)
    v_dot2_f32_bf16 v8, v40, v7, v8
    v_dot2_f32_bf16 v10, v40, v40, v10
    v_dot2_f32_bf16 v9, v41, v7, v9
    v_dot2_f32_bf16 v11, v41, v41, v11
    v_dot2_f32_bf16 v8, v42, v7, v8
    v_dot2_f32_bf16 v10, v42, v42, v10
    v_dot2_f32_bf16 v9, v43, v7, v9
    v_dot2_f32_bf16 v11, v43, v43, v11
    s_waitcnt vmcnt(10)
    v_dot2_f32_bf16 v8, v44, v7, v8
    v_dot2_f32_bf16 v10, v44, v44, v10
    v_dot2_f32_bf16 v9, v45, v7, v9
    v_dot2_f32_bf16 v11, v45, v45, v11
    v_dot2_f32_bf16 v8, v46, v7, v8
    v_dot2_f32_bf16 v10, v46, v46, v10
    v_dot2_f32_bf16 v9, v47, v7, v9
    v_dot2_f32_bf16 v11, v47, v47, v11
    s_waitcnt vmcnt(9)
    v_dot2_f32_bf16 v8, v48, v7, v8
    v_dot2_f32_bf16 v10, v48, v48, v10
    v_dot2_f32_bf16 v9, v49, v7, v9
    v_dot2_f32_bf16 v11, v49, v49, v11
    v_dot2_f32_bf16 v8, v50, v7, v8
    v_dot2_f32_bf16 v10, v50, v50, v10
    v_dot2_f32_bf16 v9, v51, v7, v9
    v_dot2_f32_bf16 v11, v51, v51, v11
    s_waitcnt vmcnt(8)
    v_dot2_f32_bf16 v8, v52, v7, v8
    v_dot2_f32_bf16 v10, v52, v52, v10
    v_dot2_f32_bf16 v9, v53, v7, v9
    v_dot2_f32_bf16 v11, v53, v53, v11
    v_dot2_f32_bf16 v8, v54, v7, v8
    v_dot2_f32_bf16 v10, v54, v54, v10
    v_dot2_f32_bf16 v9, v55, v7, v9
    v_dot2_f32_bf16 v11, v55, v55, v11
    s_waitcnt vmcnt(7)
    v_dot2_f32_bf16 v8, v56, v7, v8
    v_dot2_f32_bf16 v10, v56, v56, v10
    v_dot2_f32_bf16 v9, v57, v7, v9
    v_dot2_f32_bf16 v11, v57, v57, v11
    v_dot2_f32_bf16 v8, v58, v7, v8
    v_dot2_f32_bf16 v10, v58, v58, v10
    v_dot2_f32_bf16 v9, v59, v7, v9
    v_dot2_f32_bf16 v11, v59, v59, v11
    s_waitcnt vmcnt(6)
    v_dot2_f32_bf16 v12, v60, v7, v12
    v_dot2_f32_bf16 v14, v60, v60, v14
    v_dot2_f32_bf16 v13, v61, v7, v13
    v_dot2_f32_bf16 v15, v61, v61, v15
    v_dot2_f32_bf16 v12, v62, v7, v12
    v_dot2_f32_bf16 v14, v62, v62, v14
    v_dot2_f32_bf16 v13, v63, v7, v13
    v_dot2_f32_bf16 v15, v63, v63, v15
    s_waitcnt vmcnt(5)
    v_dot2_f32_bf16 v12, v64, v7, v12
    v_dot2_f32_bf16 v14, v64, v64, v14
    v_dot2_f32_bf16 v13, v65, v7, v13
    v_dot2_f32_bf16 v15, v65, v65, v15
    v_dot2_f32_bf16 v12, v66, v7, v12
    v_dot2_f32_bf16 v14, v66, v66, v14
    v_dot2_f32_bf16 v13, v67, v7, v13
    v_dot2_f32_bf16 v15, v67, v67, v15
    s_waitcnt vmcnt(4)
    v_dot2_f32_bf16 v12, v68, v7, v12
    v_dot2_f32_bf16 v14, v68, v68, v14
    v_dot2_f32_bf16 v13, v69, v7, v13
    v_dot2_f32_bf16 v15, v69, v69, v15
    v_dot2_f32_bf16 v12, v70, v7, v12
    v_dot2_f32_bf16 v14, v70, v70, v14
    v_dot2_f32_bf16 v13, v71, v7, v13
    v_dot2_f32_bf16 v15, v71, v71, v15
    s_waitcnt vmcnt(3)
    v_dot2_f32_bf16 v12, v72, v7, v12
    v_dot2_f32_bf16 v14, v72, v72, v14
    v_dot2_f32_bf16 v13, v73, v7, v13
    v_dot2_f32_bf16 v15, v73, v73, v15
    v_dot2_f32_bf16 v12, v74, v7, v12
    v_dot2_f32_bf16 v14, v74, v74, v14
    v_dot2_f32_bf16 v13, v75, v7, v13
    v_dot2_f32_bf16 v15, v75, v75, v15
    s_waitcnt vmcnt(2)
    v_dot2_f32_bf16 v12, v76, v7, v12
    v_dot2_f32_bf16 v14, v76, v76, v14
    v_dot2_f32_bf16 v13, v77, v7, v13
    v_dot2_f32_bf16 v15, v77, v77, v15
    v_dot2_f32_bf16 v12, v78, v7, v12
    v_dot2_f32_bf16 v14, v78, v78, v14
    v_dot2_f32_bf16 v13, v79, v7, v13
    v_dot2_f32_bf16 v15, v79, v79, v15
    s_waitcnt vmcnt(1)
    v_dot2_f32_bf16 v12, v80, v7, v12
    v_dot2_f32_bf16 v14, v80, v80, v14
    v_dot2_f32_bf16 v13, v81, v7, v13
    v_dot2_f32_bf16 v15, v81, v81, v15
    v_dot2_f32_bf16 v12, v82, v7, v12
    v_dot2_f32_bf16 v14, v82, v82, v14
    v_dot2_f32_bf16 v13, v83, v7, v13
    v_dot2_f32_bf16 v15, v83, v83, v15
    s_waitcnt vmcnt(0)
    v_dot2_f32_bf16 v12, v84, v7, v12
    v_dot2_f32_bf16 v14, v84, v84, v14
    v_dot2_f32_bf16 v13, v85, v7, v13
    v_dot2_f32_bf16 v15, v85, v85, v15
    v_dot2_f32_bf16 v12, v86, v7, v12
    v_dot2_f32_bf16 v14, v86, v86, v14
    v_dot2_f32_bf16 v13, v87, v7, v13
    v_dot2_f32_bf16 v15, v87, v87, v15
    s_nop 2
    v_add_f32 v16, v8, v9
    v_add_f32 v18, v10, v11
    v_add_f32 v17, v12, v13
    v_add_f32 v19, v14, v15
    v_nop_e64
    v_add_f32_dpp v16, v16, v16 quad_perm:[1,0,3,2] row_mask:0xf bank_mask:0xf
    v_add_f32_dpp v17, v17, v17 quad_perm:[1,0,3,2] row_mask:0xf bank_mask:0xf
    v_add_f32_dpp v18, v18, v18 quad_perm:[1,0,3,2] row_mask:0xf bank_mask:0xf
    v_add_f32_dpp v19, v19, v19 quad_perm:[1,0,3,2] row_mask:0xf bank_mask:0xf
    v_nop_e64
    v_add_f32_dpp v16, v16, v16 quad_perm:[2,3,0,1] row_mask:0xf bank_mask:0xf
    v_add_f32_dpp v17, v17, v17 quad_perm:[2,3,0,1] row_mask:0xf bank_mask:0xf
    v_add_f32_dpp v18, v18, v18 quad_perm:[2,3,0,1] row_mask:0xf bank_mask:0xf
    v_add_f32_dpp v19, v19, v19 quad_perm:[2,3,0,1] row_mask:0xf bank_mask:0xf
    v_nop_e64
    v_add_f32_dpp v16, v16, v16 row_half_mirror row_mask:0xf bank_mask:0xf
    v_add_f32_dpp v17, v17, v17 row_half_mirror row_mask:0xf bank_mask:0xf
    v_add_f32_dpp v18, v18, v18 row_half_mirror row_mask:0xf bank_mask:0xf
    v_add_f32_dpp v19, v19, v19 row_half_mirror row_mask:0xf bank_mask:0xf
    s_mov_b32 s5, 0x3b124925
    s_mov_b32 s6, 0x3727c5ac
    v_readfirstlane_b32 s47, v24
    s_nop 0
    s_add_u32 s47, s47, 1
    v_mul_f32 v16, s5, v16
    v_mul_f32 v18, s5, v18
    v_fma_f32 v18, -v16, v16, v18
    v_max_f32 v18, 0, v18
    v_cvt_pk_bf16_f32 v18, v18, v18
    v_lshlrev_b32 v18, 16, v18
    v_add_f32 v18, s6, v18
    v_cvt_pk_bf16_f32 v18, v18, v18
    v_lshlrev_b32 v18, 16, v18
    v_sqrt_f32 v18, v18
    v_nop_e64
    v_cvt_pk_bf16_f32 v20, v18, v16
    v_mov_b32 v21, s47
    v_mul_f32 v17, s5, v17
    v_mul_f32 v19, s5, v19
    v_fma_f32 v19, -v17, v17, v19
    v_max_f32 v19, 0, v19
    v_cvt_pk_bf16_f32 v19, v19, v19
    v_lshlrev_b32 v19, 16, v19
    v_add_f32 v19, s6, v19
    v_cvt_pk_bf16_f32 v19, v19, v19
    v_lshlrev_b32 v19, 16, v19
    v_sqrt_f32 v19, v19
    s_nop 0
    v_cvt_pk_bf16_f32 v22, v19, v17
    v_mov_b32 v23, s47
    s_lshl_b32 s4, s4, 7
    s_add_u32 s4, s4, 16384
    v_and_b32 v5, 1, v1
    v_cmp_eq_u32 vcc, 1, v5
    v_lshlrev_b32 v4, 3, v4
    v_lshl_add_u32 v4, v5, 6, v4
    v_cndmask_b32_e64 v20, v20, v22, vcc
    s_mov_b32 exec_lo, 0x03030303
    s_mov_b32 exec_hi, 0x03030303
    buffer_store_dwordx2 v[20:21], v4, s[32:35], s4 offen sc1
    s_mov_b64 exec, -1
    s_sub_u32 s5, s2, 224
    s_lshl_b32 s5, s5, 2
    s_add_u32 s5, s5, s3
    s_mul_i32 s5, s5, 3072
    s_add_u32 s5, s5, 11075584
    v_lshlrev_b32 v2, 7, v1
    s_mov_b64 exec, 0xffffff
    buffer_load_dword v3, v2, s[32:35], s5 offen sc1
    s_mov_b64 exec, -1
    s_mov_b32 s26, 1605632
    s_mov_b32 s27, 0x20000
    s_sub_u32 s4, s49, 28
    s_mul_i32 s4, s4, 401408
    s_lshl_b32 s5, s3, 10
    s_add_u32 s4, s4, s5
    s_add_u32 s4, s4, 372736
    s_mov_b32 s26, 1605632
    s_mov_b32 s27, 0x20000
    s_sub_u32 s7, s2, 224
    s_lshl_b32 s7, s7, 2
    s_add_u32 s7, s7, s3
    s_mul_i32 s7, s7, 12544
    v_lshlrev_b32 v26, 7, v1
    buffer_load_dword v27, v26, s[24:27], s7 offen
    s_add_u32 s7, s7, 8192
    s_mov_b32 exec_hi, 3
    buffer_load_dword v28, v26, s[24:27], s7 offen
    s_mov_b64 exec, -1
    v_lshlrev_b32 v2, 4, v1
    v_lshlrev_b32 v5, 7, v0
    s_mov_b32 s5, 0
L_pf:
    buffer_load_dwordx4 v[32:35], v2, s[24:27], s4 offen
    s_add_u32 s4, s4, 4096
    buffer_load_dwordx4 v[36:39], v2, s[24:27], s4 offen
    s_add_u32 s4, s4, 4096
    buffer_load_dwordx4 v[40:43], v2, s[24:27], s4 offen
    s_add_u32 s4, s4, 4096
    buffer_load_dwordx4 v[44:47], v2, s[24:27], s4 offen
    s_add_u32 s4, s4, 4096
    buffer_load_dwordx4 v[48:51], v2, s[24:27], s4 offen
    s_add_u32 s4, s4, 4096
    buffer_load_dwordx4 v[52:55], v2, s[24:27], s4 offen
    s_add_u32 s4, s4, 4096
    buffer_load_dwordx4 v[56:59], v2, s[24:27], s4 offen
    s_add_u32 s4, s4, 4096
    buffer_load_dword v3, v5, s[76:79], 0 offen
    s_waitcnt vmcnt(8)
    s_add_u32 s5, s5, 1
    s_cmp_lt_u32 s5, 1
    s_cbranch_scc1 L_pf
    s_cmp_ge_u32 s49, 29
    s_cbranch_scc1 L_keepd
    v_lshlrev_b32 v5, 7, v0
    v_mov_b32 v6, 0
    s_lshl_b32 s4, s48, 8
    s_add_u32 s4, s4, 11337728
    s_mov_b32 s5, 0
L_keep:
    buffer_load_dword v3, v5, s[76:79], 0 offen
    s_mov_b64 exec, 1
    buffer_load_dword v4, v6, s[32:35], s4 offen sc1
    s_mov_b64 exec, -1
    s_waitcnt vmcnt(0)
    v_readfirstlane_b32 s6, v4
    s_add_u32 s5, s5, 1
    s_cmp_gt_u32 s5, 200
    s_cbranch_scc1 L_keepd
    s_cmp_lg_u32 s6, s47
    s_cbranch_scc1 L_keep
L_keepd:
    s_cmp_lg_u32 s2, 255
    s_cbranch_scc1 L_hdone
    s_cmp_lg_u32 s3, 0
    s_cbranch_scc1 L_hdone
    v_lshlrev_b32_e64 v2, 7, v1
    s_mov_b32 s71, 0
L_chk:
    s_mov_b32 s6, 11075584
    buffer_load_dword v32, v2, s[32:35], s6 offen sc1
    s_add_u32 s6, s6, 8192
    buffer_load_dword v33, v2, s[32:35], s6 offen sc1
    s_add_u32 s6, s6, 8192
    buffer_load_dword v34, v2, s[32:35], s6 offen sc1
    s_add_u32 s6, s6, 8192
    buffer_load_dword v35, v2, s[32:35], s6 offen sc1
    s_add_u32 s6, s6, 8192
    buffer_load_dword v36, v2, s[32:35], s6 offen sc1
    s_add_u32 s6, s6, 8192
    buffer_load_dword v37, v2, s[32:35], s6 offen sc1
    s_add_u32 s6, s6, 8192
    buffer_load_dword v38, v2, s[32:35], s6 offen sc1
    s_add_u32 s6, s6, 8192
    buffer_load_dword v39, v2, s[32:35], s6 offen sc1
    s_add_u32 s6, s6, 8192
    buffer_load_dword v40, v2, s[32:35], s6 offen sc1
    s_add_u32 s6, s6, 8192
    buffer_load_dword v41, v2, s[32:35], s6 offen sc1
    s_add_u32 s6, s6, 8192
    buffer_load_dword v42, v2, s[32:35], s6 offen sc1
    s_add_u32 s6, s6, 8192
    buffer_load_dword v43, v2, s[32:35], s6 offen sc1
    s_add_u32 s6, s6, 8192
    buffer_load_dword v44, v2, s[32:35], s6 offen sc1
    s_add_u32 s6, s6, 8192
    buffer_load_dword v45, v2, s[32:35], s6 offen sc1
    s_add_u32 s6, s6, 8192
    s_mov_b32 s6, 16388
    buffer_load_dword v46, v2, s[32:35], s6 offen sc1
    s_mov_b32 s6, 24580
    buffer_load_dword v47, v2, s[32:35], s6 offen sc1
    s_waitcnt vmcnt(0)
    v_mov_b32 v3, 0
    v_xor_b32 v32, s47, v32
    v_or_b32 v3, v3, v32
    v_xor_b32 v33, s47, v33
    v_or_b32 v3, v3, v33
    v_xor_b32 v34, s47, v34
    v_or_b32 v3, v3, v34
    v_xor_b32 v35, s47, v35
    v_or_b32 v3, v3, v35
    v_xor_b32 v36, s47, v36
    v_or_b32 v3, v3, v36
    v_xor_b32 v37, s47, v37
    v_or_b32 v3, v3, v37
    v_xor_b32 v38, s47, v38
    v_or_b32 v3, v3, v38
    v_xor_b32 v39, s47, v39
    v_or_b32 v3, v3, v39
    v_xor_b32 v40, s47, v40
    v_or_b32 v3, v3, v40
    v_xor_b32 v41, s47, v41
    v_or_b32 v3, v3, v41
    v_xor_b32 v42, s47, v42
    v_or_b32 v3, v3, v42
    v_xor_b32 v43, s47, v43
    v_or_b32 v3, v3, v43
    v_xor_b32 v44, s47, v44
    v_or_b32 v3, v3, v44
    v_xor_b32 v45, s47, v45
    v_or_b32 v3, v3, v45
    v_xor_b32 v46, s47, v46
    v_or_b32 v3, v3, v46
    v_xor_b32 v47, s47, v47
    v_or_b32 v3, v3, v47
    v_cmp_ne_u32 vcc, 0, v3
    s_add_u32 s71, s71, 1
    s_cmp_gt_u32 s71, 0x40000
    s_cbranch_vccz L_chkd
    s_sleep 8
    s_cbranch_scc0 L_chk
L_chkd:
    v_mov_b32 v2, s47
    v_lshlrev_b32 v3, 2, v1
    s_mov_b32 exec_hi, 0
    buffer_store_dword v2, v3, s[32:35], 0 offen sc1
    s_mov_b64 exec, -1
L_hdone:
L_end:
    s_endpgm
L_codeend:
.section .rodata,"a"
.p2align 6
.amdhsa_kernel parallel_sum__ssm_conv_h3__dense_activation_silu__prompt_kernel
  .amdhsa_next_free_vgpr 512
  .amdhsa_next_free_sgpr 102
  .amdhsa_accum_offset 256
  .amdhsa_group_segment_fixed_size 0
  .amdhsa_kernarg_size 96
  .amdhsa_user_sgpr_count 2
  .amdhsa_user_sgpr_kernarg_segment_ptr 1
  .amdhsa_system_sgpr_workgroup_id_x 1
.end_amdhsa_kernel
```
